```python
import torch

def _softmax(x, axis=-1):
    return torch.softmax(x, dim=axis)
def _gelu(x):
    return torch.nn.functional.gelu(x, approximate="tanh")
def _silu(x):
    return torch.nn.functional.silu(x)
def _sigmoid(x):
    return torch.sigmoid(x)
def _layernorm(x, axis=-1, eps=1e-5):
    m = x.mean(dim=axis, keepdim=True)
    v = x.var(dim=axis, keepdim=True, unbiased=False)
    return (x - m) / torch.sqrt(v + eps)
def _scatter_add(tgt, idx, src, axis=0):
    return tgt.clone().index_add_(axis, idx, src)
def _segment_sum(src, seg, n):
    out = torch.zeros((n,) + src.shape[1:], dtype=src.dtype)
    return out.index_add_(0, seg, src)
def _pad(x, pw):
    flat = tuple(v for pair in reversed(pw) for v in pair)
    return torch.nn.functional.pad(x, flat)

kernel_name = 'interleave_layers__gqa_block_cached__geglu_ffn__decode'

def setup_inputs():

    _w = (lambda a: (lambda t: t.to(torch.bfloat16) if t.is_floating_point() else t)(torch.as_tensor(a)))
    def _A_setup():
        B, Sq, D = 4, 1, 448
        Hq, Hkv, Sk, Dh = 16, 8, 4096, 256
        assert Hq % Hkv == 0, (Hq, Hkv)
        return {
            "x": _w((lambda *s: torch.randn(*s, dtype=torch.bfloat16) * 0.05)(B, Sq, D)),
            "k_cache": _w((lambda *s: torch.randn(*s, dtype=torch.bfloat16) * 1.6)(B, Hkv, Sk, Dh)),
            "v_cache": _w((lambda *s: torch.randn(*s, dtype=torch.bfloat16) * 1.6)(B, Hkv, Sk, Dh)),
            "wq": _w((lambda *s: torch.randn(*s, dtype=torch.bfloat16) * 1.6)(D, Hq * Dh) * (D ** -0.5)),
            "wo": _w((lambda *s: torch.randn(*s, dtype=torch.bfloat16) * 1.6)(Hq * Dh, D) * ((Hq * Dh) ** -0.5)),
        }
    _A_in = _A_setup()

    def _B_setup():
        B, S, D, F = 4, 1, 448, 1792
        return {
            "x": _w((lambda *s: torch.randn(*s, dtype=torch.bfloat16) * 0.05)(B, S, D)),
            "w_gate": _w((lambda *s: torch.randn(*s, dtype=torch.bfloat16) * 0.05)(D, F)),
            "w_up": _w((lambda *s: torch.randn(*s, dtype=torch.bfloat16) * 0.05)(D, F)),
            "w_down": _w((lambda *s: torch.randn(*s, dtype=torch.bfloat16) * 0.05)(F, D)),
        }
    _B_in = _B_setup()

    return {
        "A_x": _A_in["x"],
        "A_k_cache": _A_in["k_cache"],
        "A_v_cache": _A_in["v_cache"],
        "A_wq": _A_in["wq"],
        "A_wo": _A_in["wo"],
        "B_x": _B_in["x"],
        "B_w_gate": _B_in["w_gate"],
        "B_w_up": _B_in["w_up"],
        "B_w_down": _B_in["w_down"],
    }

def reference(A_x, A_k_cache, A_v_cache, A_wq, A_wo, B_x, B_w_gate, B_w_up, B_w_down):
    def _A_ref(x, k_cache, v_cache, wq, wo):
        B, Sq, D = x.shape
        Hq, Dh = 16, 256
        Hkv = k_cache.shape[1]
        rep = Hq // Hkv
        q = (lambda x, *d: x.permute(*d))((x @ wq).reshape(B, Sq, Hq, Dh), 0, 2, 1, 3)
        k = (lambda x, n, axis: torch.repeat_interleave(x, n, dim=axis))(k_cache, rep, axis=1)
        v = (lambda x, n, axis: torch.repeat_interleave(x, n, dim=axis))(v_cache, rep, axis=1)
        scores = torch.einsum("bhqd,bhkd->bhqk", q, k) * (Dh ** -0.5)
        p = _softmax(scores, axis=-1)
        o = torch.einsum("bhqk,bhkd->bhqd", p, v)
        return (lambda x, *d: x.permute(*d))(o, 0, 2, 1, 3).reshape(B, Sq, Hq * Dh) @ wo

    def _B_ref(x, w_gate, w_up, w_down):
        return (_gelu(x @ w_gate) * (x @ w_up)) @ w_down

    x = A_x
    x = x + _A_ref(_layernorm(x, axis=-1), A_k_cache, A_v_cache, A_wq, A_wo)
    x = x + _B_ref(_layernorm(x, axis=-1), B_w_gate, B_w_up, B_w_down)
    x = x + _A_ref(_layernorm(x, axis=-1), A_k_cache, A_v_cache, A_wq, A_wo)
    x = x + _B_ref(_layernorm(x, axis=-1), B_w_gate, B_w_up, B_w_down)
    return x
```

```asm
; @launch grid=(256,1,1) block=(256,1,1) lds=163840
.amdgcn_target "amdgcn-amd-amdhsa--gfx950"
.text
.globl interleave_layers__gqa_block_cached__geglu_ffn__decode_kernel
.p2align 8
.type interleave_layers__gqa_block_cached__geglu_ffn__decode_kernel,@function
interleave_layers__gqa_block_cached__geglu_ffn__decode_kernel:
    s_cmp_ge_u32 s2, 256
    s_cbranch_scc1 L_end
    s_load_dwordx16 s[48:63], s[0:1], 0
    s_load_dwordx8 s[64:71], s[0:1], 64
    s_getpc_b64 s[90:91]
L_pc0:
    v_lshlrev_b32 v56, 7, v0
    v_min_u32 v56, L_end-L_pc0, v56
    global_load_dword v91, v56, s[90:91]
    v_and_b32 v1, 63, v0
    v_lshrrev_b32 v56, 6, v0
    s_nop 0
    v_readfirstlane_b32 s72, v56
    s_getreg_b32 s73, hwreg(HW_REG_XCC_ID)
    s_and_b32 s73, s73, 7
    s_mov_b32 s79, 400000
    s_mov_b32 s86, 0x3db8aa3b
    s_lshl_b32 s93, s73, 15
    s_mov_b32 s98, 0x3fff3fff
    s_mov_b32 s99, 0x3fff3fff
    s_mov_b32 s100, -1
    s_mov_b32 s101, 0xffffff
    s_mov_b32 s80, 0x000f000f
    s_mov_b32 s81, 0x000f000f
    s_mov_b32 s82, 0x000f000f
    s_mov_b32 s83, 0
    s_mov_b32 s84, -1
    s_cmp_eq_u32 s72, 3
    s_cselect_b32 s85, 0, -1
    v_lshlrev_b32 v8, 4, v1
    v_and_b32 v56, 15, v1
    v_lshrrev_b32 v57, 4, v1
    s_lshl_b32 s77, s72, 16
    v_lshrrev_b32 v58, 2, v56
    v_lshlrev_b32 v58, 11, v58
    v_bfe_u32 v60, v56, 1, 1
    v_lshl_add_u32 v58, v60, 9, v58
    v_and_b32 v60, 1, v56
    v_lshl_add_u32 v58, v60, 6, v58
    v_lshl_add_u32 v58, v57, 4, v58
    v_add_u32 v6, s77, v58
    v_lshlrev_b32 v58, 11, v57
    v_lshl_add_u32 v58, v56, 4, v58
    v_add_u32 v7, s77, v58
    s_waitcnt lgkmcnt(0)
    s_mov_b32 s44, s68
    s_and_b32 s45, s69, 0xffff
    s_mov_b32 s46, 256
    s_mov_b32 s47, 0x20000
    s_mov_b32 s16, s48
    s_and_b32 s17, s49, 0xffff
    s_mov_b32 s18, 3584
    s_mov_b32 s19, 0x20000
    v_lshlrev_b32 v59, 4, v0
    buffer_load_dwordx4 v[60:63], v59, s[16:19], 0 offen
    s_lshr_b32 s74, s2, 3
    s_and_b32 s74, s74, 31
    s_lshl_b32 s3, s73, 4
    s_add_u32 s3, s3, 128
    s_lshl_b32 s77, 1, s74
    v_mov_b32 v82, s77
    s_cmp_lg_u32 s72, 0
    s_cbranch_scc1 Lsk_1
    s_mov_b64 exec, 1
    buffer_atomic_or v82, off, s[44:47], s3 sc0 sc1
    s_mov_b64 exec, -1
Lsk_1:
L_role:
    s_lshr_b32 s75, s74, 3
    s_and_b32 s76, s74, 7
    s_lshl_b32 s96, s74, 3
    s_add_u32 s96, s96, s73
    s_lshl_b32 s87, s96, 15
    s_add_u32 s87, s87, 524288
    s_mul_i32 s97, s73, 28
    s_add_u32 s97, s97, s74
    s_lshl_b32 s77, s75, 3
    s_add_u32 s77, s77, s73
    s_lshl_b32 s77, s77, 21
    s_lshl_b32 s78, s76, 18
    s_add_u32 s77, s77, s78
    s_add_u32 s50, s50, s77
    s_addc_u32 s51, s51, 0
    s_add_u32 s52, s52, s77
    s_addc_u32 s53, s53, 0
    s_mov_b32 s4, s50
    s_and_b32 s5, s51, 0xffff
    s_mov_b32 s6, 262144
    s_mov_b32 s7, 0x20000
    s_mov_b32 s8, s52
    s_and_b32 s9, s53, 0xffff
    s_mov_b32 s10, 262144
    s_mov_b32 s11, 0x20000
    s_mov_b32 s12, s70
    s_and_b32 s13, s71, 0xffff
    s_mov_b32 s14, 33554432
    s_mov_b32 s15, 0x20000
    s_mov_b32 s20, s54
    s_and_b32 s21, s55, 0xffff
    s_mov_b32 s22, 3670016
    s_mov_b32 s23, 0x20000
    s_mov_b32 s24, s56
    s_and_b32 s25, s57, 0xffff
    s_mov_b32 s26, 3670016
    s_mov_b32 s27, 0x20000
    s_mov_b32 s28, s60
    s_and_b32 s29, s61, 0xffff
    s_mov_b32 s30, 1605632
    s_mov_b32 s31, 0x20000
    s_mov_b32 s32, s62
    s_and_b32 s33, s63, 0xffff
    s_mov_b32 s34, 1605632
    s_mov_b32 s35, 0x20000
    s_mov_b32 s36, s64
    s_and_b32 s37, s65, 0xffff
    s_mov_b32 s38, 1605632
    s_mov_b32 s39, 0x20000
    s_mov_b32 s40, s66
    s_and_b32 s41, s67, 0xffff
    s_mov_b32 s42, 3584
    s_mov_b32 s43, 0x20000
    s_mov_b64 s[60:61], -1
    s_mov_b32 s62, s72
    s_mov_b32 s63, 0
    s_mov_b32 s66, 0
    s_mov_b32 s67, 0
    s_mov_b32 s68, 0
    s_mov_b32 s69, 0
    s_mov_b32 s70, 0
    s_mov_b32 s71, 0
    s_add_u32 s77, s74, s72
    s_add_u32 s77, s77, s73
    s_add_u32 s48, s77, 0
    s_and_b32 s48, s48, 7
    s_lshl_b32 s48, s48, 13
    s_add_u32 s49, s77, 1
    s_and_b32 s49, s49, 7
    s_lshl_b32 s49, s49, 13
    s_add_u32 s50, s77, 2
    s_and_b32 s50, s50, 7
    s_lshl_b32 s50, s50, 13
    s_add_u32 s51, s77, 3
    s_and_b32 s51, s51, 7
    s_lshl_b32 s51, s51, 13
    s_add_u32 s52, s77, 4
    s_and_b32 s52, s52, 7
    s_lshl_b32 s52, s52, 13
    s_add_u32 s53, s77, 5
    s_and_b32 s53, s53, 7
    s_lshl_b32 s53, s53, 13
    s_add_u32 s54, s77, 6
    s_and_b32 s54, s54, 7
    s_lshl_b32 s54, s54, 13
    s_add_u32 s55, s77, 7
    s_and_b32 s55, s55, 7
    s_lshl_b32 s55, s55, 13
    s_mul_i32 s56, s72, 24576
    s_add_u32 s56, s56, 65536
    s_cmp_eq_u32 s72, 0
    s_cselect_b32 s57, 0, 3
    v_mov_b32 v68, -1
    v_mov_b32 v69, -1
    v_mov_b32 v70, -1
    v_mov_b32 v71, -1
    s_lshl_b32 s89, s72, 10
    s_add_u32 s89, s89, s87
    s_lshl_b32 s88, s74, 10
    s_add_u32 s88, s88, s93
    s_cmp_eq_u32 s72, 2
    s_cselect_b32 s71, s88, s89
    s_cmp_eq_u32 s72, 3
    s_cbranch_scc1 Lr_2
    buffer_store_dwordx4 v[68:71], v8, s[12:15], s71 offen
    s_branch Lr_3
Lr_2:
    s_lshl_b32 s89, s96, 10
    s_add_u32 s89, s89, 262144
    buffer_store_dwordx4 v[68:71], v8, s[12:15], s89 offen sc1
Lr_3:
    s_mul_i32 s77, s72, 112
    v_lshrrev_b32 v64, 1, v1
    v_add_u32 v64, s77, v64
    v_and_b32 v66, 3, v64
    v_lshlrev_b32 v66, 3, v66
    v_bfe_u32 v65, v64, 2, 3
    v_or_b32 v66, v66, v65
    v_and_b32 v65, 0xffffffe0, v64
    v_or_b32 v65, v65, v66
    s_lshl_b32 s78, s73, 10
    s_lshl_b32 s88, s74, 5
    s_add_u32 s78, s78, s88
    v_and_b32 v66, 1, v1
    v_lshlrev_b32 v66, 4, v66
    v_lshl_add_u32 v65, v65, 13, v66
    s_mul_i32 s88, s72, 3584
    s_add_u32 s88, s88, 12288
    s_add_u32 m0, s88, 0
    s_add_u32 s89, s78, 0
    buffer_load_dwordx4 v65, s[20:23], s89 offen nt lds
    s_add_u32 m0, s88, 1024
    s_add_u32 s89, s78, 262144
    buffer_load_dwordx4 v65, s[20:23], s89 offen nt lds
    s_add_u32 m0, s88, 2048
    s_add_u32 s89, s78, 524288
    buffer_load_dwordx4 v65, s[20:23], s89 offen nt lds
    s_add_u32 m0, s88, 3072
    s_and_b32 exec_lo, s60, 0xffffffff
    s_and_b32 exec_hi, s60, 0x0
    s_add_u32 s89, s78, 786432
    buffer_load_dwordx4 v65, s[20:23], s89 offen nt lds
    s_mov_b64 exec, -1
    buffer_load_dwordx4 v[96:99], v6, s[4:7], s48 offen offset:0 nt
    buffer_load_dwordx4 v[100:103], v6, s[4:7], s48 offen offset:128 nt
    buffer_load_dwordx4 v[104:107], v6, s[4:7], s48 offen offset:256 nt
    buffer_load_dwordx4 v[108:111], v6, s[4:7], s48 offen offset:384 nt
    buffer_load_dwordx4 v[112:115], v6, s[4:7], s48 offen offset:1024 nt
    buffer_load_dwordx4 v[116:119], v6, s[4:7], s48 offen offset:1152 nt
    buffer_load_dwordx4 v[120:123], v6, s[4:7], s48 offen offset:1280 nt
    buffer_load_dwordx4 v[124:127], v6, s[4:7], s48 offen offset:1408 nt
    buffer_load_dwordx4 v[128:131], v6, s[4:7], s49 offen offset:0 nt
    buffer_load_dwordx4 v[132:135], v6, s[4:7], s49 offen offset:128 nt
    buffer_load_dwordx4 v[136:139], v6, s[4:7], s49 offen offset:256 nt
    buffer_load_dwordx4 v[140:143], v6, s[4:7], s49 offen offset:384 nt
    v_lshrrev_b32 v56, 4, v1
    s_lshl_b32 s77, s74, 4
    v_lshl_add_u32 v56, v56, 2, s77
    v_and_b32 v58, 3, v56
    v_lshlrev_b32 v58, 3, v58
    v_bfe_u32 v57, v56, 2, 3
    v_or_b32 v58, v58, v57
    v_and_b32 v57, 0xffffffe0, v56
    v_or_b32 v57, v57, v58
    s_lshl_b32 s77, s73, 9
    v_add_u32 v57, s77, v57
    v_mul_u32_u24 v57, 896, v57
    v_and_b32 v58, 15, v1
    v_lshl_add_u32 v57, v58, 4, v57
    s_lshl_b32 s77, s72, 8
    s_lshl_b32 s88, s72, 12
    s_add_u32 m0, s88, 40960
    s_add_u32 s89, s77, 0
    buffer_load_dwordx4 v57, s[24:27], s89 offen nt lds
    s_add_u32 m0, s88, 41984
    s_add_u32 s89, s77, 7168
    buffer_load_dwordx4 v57, s[24:27], s89 offen nt lds
    s_add_u32 m0, s88, 43008
    s_add_u32 s89, s77, 14336
    buffer_load_dwordx4 v57, s[24:27], s89 offen nt lds
    s_add_u32 m0, s88, 44032
    s_add_u32 s89, s77, 21504
    buffer_load_dwordx4 v57, s[24:27], s89 offen nt lds
    v_and_b32 v56, 15, v1
    v_lshrrev_b32 v57, 4, v1
    v_and_b32 v58, 1, v1
    v_cmp_eq_u32 vcc, 1, v58
    v_mov_b32 v58, 0xffff
    v_mov_b32 v64, 0xffff0000
    v_cndmask_b32 v58, v58, v64, vcc
    v_bfe_u32 v64, v1, 1, 2
    v_cmp_eq_u32 vcc, 0, v64
    s_nop 1
    v_cndmask_b32 v2, 0, v58, vcc
    v_cmp_eq_u32 vcc, 1, v64
    s_nop 1
    v_cndmask_b32 v3, 0, v58, vcc
    v_cmp_eq_u32 vcc, 2, v64
    s_nop 1
    v_cndmask_b32 v4, 0, v58, vcc
    v_cmp_eq_u32 vcc, 3, v64
    s_nop 1
    v_cndmask_b32 v5, 0, v58, vcc
    v_mul_u32_u24 v58, 896, v56
    v_lshl_add_u32 v58, v57, 4, v58
    s_mul_i32 s77, s72, 224
    v_add_u32 v10, s77, v58
    s_mul_i32 s77, s72, 112
    v_lshrrev_b32 v58, 2, v56
    v_add_u32 v58, s77, v58
    v_and_b32 v64, 1, v57
    v_lshl_add_u32 v64, v64, 3, v58
    v_lshl_add_u32 v58, v57, 3, v58
    v_and_b32 v65, 3, v56
    v_lshlrev_b32 v66, 5, v58
    v_lshl_add_u32 v66, v65, 3, v66
    v_add_u32 v11, 12288, v66
    v_lshlrev_b32 v66, 4, v58
    v_and_b32 v67, 1, v65
    v_lshl_add_u32 v66, v67, 3, v66
    v_lshrrev_b32 v67, 1, v65
    v_mul_u32_u24 v67, 7168, v67
    v_add3_u32 v12, v66, v67, 0
    v_add_u32 v12, 26624, v12
    v_lshlrev_b32 v66, 5, v64
    v_lshl_add_u32 v66, v65, 3, v66
    v_add_u32 v13, 12288, v66
    v_lshlrev_b32 v66, 4, v64
    v_and_b32 v67, 1, v65
    v_lshl_add_u32 v66, v67, 3, v66
    v_lshrrev_b32 v67, 1, v65
    v_mul_u32_u24 v67, 7168, v67
    v_add3_u32 v14, v66, v67, 0
    v_add_u32 v14, 26624, v14
    v_lshlrev_b32 v58, 10, v57
    v_lshl_add_u32 v58, v56, 4, v58
    s_lshl_b32 s77, s72, 2
    v_add_u32 v15, s77, v58
    s_mul_i32 s77, s72, 24576
    s_add_u32 s77, s77, 65536
    v_add_u32 v92, s77, v8
    v_mul_u32_u24 v56, 1171, v0
    v_lshrrev_b32 v56, 16, v56
    v_mul_u32_u24 v57, 56, v56
    v_sub_u32 v57, v0, v57
    v_mul_u32_u24 v56, 896, v56
    v_lshrrev_b32 v58, 2, v57
    v_lshl_add_u32 v56, v58, 6, v56
    v_and_b32 v58, 3, v57
    v_lshl_add_u32 v56, v58, 1, v56
    s_waitcnt vmcnt(21)
    v_cmp_gt_u32 vcc, 224, v0
    s_and_saveexec_b64 s[90:91], vcc
    ds_write_b16 v56, v60 offset:8192
    ds_write_b16_d16_hi v56, v60 offset:8200
    ds_write_b16 v56, v61 offset:8208
    ds_write_b16_d16_hi v56, v61 offset:8216
    ds_write_b16 v56, v62 offset:8224
    ds_write_b16_d16_hi v56, v62 offset:8232
    ds_write_b16 v56, v63 offset:8240
    ds_write_b16_d16_hi v56, v63 offset:8248
    s_mov_b64 exec, -1
    s_waitcnt vmcnt(16)
    s_cmp_lg_u32 s72, 0
    s_cbranch_scc1 Lsk_4
    v_lshrrev_b32 v82, s74, v82
    v_and_b32 v82, 1, v82
    v_mov_b32 v57, 0
    s_and_b32 exec_lo, s60, 0x1
    s_and_b32 exec_hi, s60, 0x0
    ds_write_b32 v57, v82 offset:12192
    s_mov_b64 exec, s[60:61]
Lsk_4:
    buffer_load_dwordx4 v[144:147], v6, s[4:7], s49 offen offset:1024 nt
    buffer_load_dwordx4 v[148:151], v6, s[4:7], s49 offen offset:1152 nt
    buffer_load_dwordx4 v[152:155], v6, s[4:7], s49 offen offset:1280 nt
    buffer_load_dwordx4 v[156:159], v6, s[4:7], s49 offen offset:1408 nt
    s_waitcnt lgkmcnt(0)
    s_barrier
    v_mov_b32 v57, 0
    ds_read_b32 v56, v57 offset:12192
    s_waitcnt lgkmcnt(0)
    v_readfirstlane_b32 s90, v56
    s_cmp_lg_u32 s90, 0
    s_cbranch_scc1 L_fix
    s_cmp_lg_u32 s72, 0
    s_cbranch_scc1 Lsk_5
    v_mov_b32 v82, 1
    s_and_b32 exec_lo, s60, 0x1
    s_and_b32 exec_hi, s60, 0x0
    buffer_atomic_add v82, off, s[44:47], s3 offset:4 sc1
    s_mov_b64 exec, s[60:61]
    v_mov_b32 v83, 0
Lsk_5:
    buffer_load_dwordx4 v[88:91], v8, s[12:15], s71 offen nt
    buffer_load_dwordx4 v[160:163], v6, s[4:7], s50 offen offset:0 nt
    buffer_load_dwordx4 v[164:167], v6, s[4:7], s50 offen offset:128 nt
    buffer_load_dwordx4 v[168:171], v6, s[4:7], s50 offen offset:256 nt
    buffer_load_dwordx4 v[172:175], v6, s[4:7], s50 offen offset:384 nt
    buffer_load_dwordx4 v[176:179], v6, s[4:7], s50 offen offset:1024 nt
    buffer_load_dwordx4 v[180:183], v6, s[4:7], s50 offen offset:1152 nt
    buffer_load_dwordx4 v[184:187], v6, s[4:7], s50 offen offset:1280 nt
    buffer_load_dwordx4 v[188:191], v6, s[4:7], s50 offen offset:1408 nt
    buffer_load_dwordx4 v[192:195], v6, s[4:7], s51 offen offset:0 nt
    buffer_load_dwordx4 v[196:199], v6, s[4:7], s51 offen offset:128 nt
    v_lshrrev_b32 v60, 3, v1
    s_mul_i32 s89, s72, 7
    v_add_u32 v60, s89, v60
    v_lshrrev_b32 v61, 1, v60
    s_mul_i32 s89, s74, 7
    v_add_u32 v61, s89, v61
    v_and_b32 v62, 1, v60
    v_bfe_u32 v63, v61, 3, 1
    v_lshl_add_u32 v62, v62, 1, v63
    v_mul_u32_u24 v62, 896, v62
    v_lshrrev_b32 v63, 4, v61
    v_lshl_add_u32 v62, v63, 6, v62
    v_and_b32 v63, 7, v61
    v_lshl_add_u32 v57, v63, 3, v62
    v_min_u32 v57, 3576, v57
    ds_read_b64 v[60:61], v57 offset:8192
    s_waitcnt lgkmcnt(0)
    v_mov_b32 v9, v60
    v_mov_b32 v0, v61
    ds_read_b64_tr_b16 v[32:33], v11 offset:0
    ds_read_b64_tr_b16 v[34:35], v11 offset:128
    ds_read_b64_tr_b16 v[36:37], v11 offset:1024
    ds_read_b64_tr_b16 v[38:39], v11 offset:1152
    ds_read_b64_tr_b16 v[40:41], v11 offset:2048
    ds_read_b64_tr_b16 v[42:43], v11 offset:2176
    ds_read_b64_tr_b16 v[44:45], v13 offset:3072
    ds_read_b64_tr_b16 v[46:47], v13 offset:3200
    v_mov_b32 v16, 0x3f803f80
    v_mov_b32 v17, 0x3f803f80
    v_mov_b32 v18, 0x3f803f80
    v_mov_b32 v19, 0x3f803f80
    v_mov_b32 v20, 0x3f803f80
    v_mov_b32 v21, 0x3f803f80
    v_mov_b32 v22, 0x3f803f80
    v_mov_b32 v23, 0x3f803f80
    v_mov_b32 v24, 0x3f803f80
    v_mov_b32 v25, 0x3f803f80
    v_mov_b32 v26, 0x3f803f80
    v_mov_b32 v27, 0x3f803f80
    v_cmp_gt_u32 vcc, 32, v1
    v_mov_b32 v56, 0x3f803f80
    s_nop 0
    v_cndmask_b32 v28, 0, v56, vcc
    v_cndmask_b32 v29, 0, v56, vcc
    v_cndmask_b32 v30, 0, v56, vcc
    v_cndmask_b32 v31, 0, v56, vcc
    buffer_load_dwordx4 v[200:203], v6, s[4:7], s51 offen offset:256 nt
    buffer_load_dwordx4 v[204:207], v6, s[4:7], s51 offen offset:384 nt
    buffer_load_dwordx4 v[208:211], v6, s[4:7], s51 offen offset:1024 nt
    buffer_load_dwordx4 v[212:215], v6, s[4:7], s51 offen offset:1152 nt
    buffer_load_dwordx4 v[216:219], v6, s[4:7], s51 offen offset:1280 nt
    buffer_load_dwordx4 v[220:223], v6, s[4:7], s51 offen offset:1408 nt
    buffer_load_dwordx4 v[224:227], v6, s[4:7], s52 offen offset:0 nt
    buffer_load_dwordx4 v[228:231], v6, s[4:7], s52 offen offset:128 nt
    buffer_load_dwordx4 v[232:235], v6, s[4:7], s52 offen offset:256 nt
    buffer_load_dwordx4 v[236:239], v6, s[4:7], s52 offen offset:384 nt
    v_add_u32 v56, 8192, v10
    s_and_b64 exec, s[80:81], s[60:61]
    ds_read_b128 v[16:19], v56 offset:0
    ds_read_b128 v[20:23], v56 offset:64
    ds_read_b128 v[24:27], v56 offset:128
    s_and_b64 exec, s[82:83], s[60:61]
    ds_read_b128 v[28:31], v56 offset:192
    s_mov_b64 exec, s[60:61]
    s_waitcnt lgkmcnt(0)
    v_mfma_f32_16x16x32_bf16 v[48:51], v[16:19], v[32:35], 0
    v_mfma_f32_16x16x32_bf16 v[52:55], v[16:19], v[16:19], 0
    v_mfma_f32_16x16x32_bf16 v[48:51], v[20:23], v[36:39], v[48:51]
    v_mfma_f32_16x16x32_bf16 v[52:55], v[20:23], v[20:23], v[52:55]
    v_mfma_f32_16x16x32_bf16 v[48:51], v[24:27], v[40:43], v[48:51]
    v_mfma_f32_16x16x32_bf16 v[52:55], v[24:27], v[24:27], v[52:55]
    v_mfma_f32_16x16x32_bf16 v[48:51], v[28:31], v[44:47], v[48:51]
    v_mfma_f32_16x16x32_bf16 v[52:55], v[28:31], v[28:31], v[52:55]
    s_nop 7
    ds_write_b32 v15, v48 offset:0
    ds_write_b32 v15, v49 offset:256
    ds_write_b32 v15, v50 offset:512
    ds_write_b32 v15, v51 offset:768
    ds_write_b32 v15, v52 offset:4096
    ds_write_b32 v15, v53 offset:4352
    ds_write_b32 v15, v54 offset:4608
    ds_write_b32 v15, v55 offset:4864
    s_waitcnt lgkmcnt(0)
    s_cbranch_execz Ld_6
    s_barrier
Ld_6:
    buffer_load_dwordx4 v[240:243], v6, s[4:7], s52 offen offset:1024 nt
    buffer_load_dwordx4 v[244:247], v6, s[4:7], s52 offen offset:1152 nt
    buffer_load_dwordx4 v[248:251], v6, s[4:7], s52 offen offset:1280 nt
    buffer_load_dwordx4 v[252:255], v6, s[4:7], s52 offen offset:1408 nt
    s_add_u32 m0, s56, 0
    s_nop 0
    buffer_load_dwordx4 v6, s[4:7], s53 offen offset:0 nt lds
    s_add_u32 m0, s56, 896
    s_nop 0
    buffer_load_dwordx4 v6, s[4:7], s53 offen offset:128 nt lds
    s_add_u32 m0, s56, 1792
    s_nop 0
    buffer_load_dwordx4 v6, s[4:7], s53 offen offset:256 nt lds
    s_add_u32 m0, s56, 2688
    s_nop 0
    buffer_load_dwordx4 v6, s[4:7], s53 offen offset:384 nt lds
    s_add_u32 m0, s56, 3072
    s_nop 0
    buffer_load_dwordx4 v6, s[4:7], s53 offen offset:1024 nt lds
    s_add_u32 m0, s56, 3968
    s_nop 0
    buffer_load_dwordx4 v6, s[4:7], s53 offen offset:1152 nt lds
    s_cmp_lg_u32 s72, 0
    s_cbranch_scc1 Lsk_7
    v_lshrrev_b32 v56, 3, v1
    v_and_b32 v57, 7, v1
    v_lshlrev_b32 v58, 5, v57
    v_lshl_add_u32 v59, v56, 8, v58
    v_mul_u32_u24 v60, 272, v56
    v_lshlrev_b32 v61, 4, v56
    ds_read_b128 v[16:19], v59 offset:0
    ds_read_b128 v[20:23], v59 offset:16
    ds_read_b128 v[24:27], v58 offset:1024
    ds_read_b128 v[28:31], v58 offset:1040
    ds_read_b128 v[32:35], v60 offset:4096
    ds_read_b128 v[36:39], v61 offset:5120
    s_waitcnt lgkmcnt(0)
    v_add_f32 v36, v36, v37
    v_add_f32 v38, v38, v39
    v_add_f32 v40, v36, v38
    v_add_f32 v32, v32, v33
    v_add_f32 v34, v34, v35
    v_add_f32 v41, v32, v34
    v_mul_f32 v40, 0x3b124925, v40
    v_mul_f32 v41, 0x3b124925, v41
    v_fma_f32 v41, -v40, v40, v41
    v_max_f32 v41, 0, v41
    v_add_f32 v41, 0x3727c5ac, v41
    v_rsq_f32 v41, v41
    v_add_f32 v16, v16, v17
    v_add_f32 v18, v18, v19
    v_add_f32 v42, v16, v18
    v_add_f32 v20, v20, v21
    v_add_f32 v22, v22, v23
    v_add_f32 v43, v20, v22
    v_add_f32 v24, v24, v25
    v_add_f32 v26, v26, v27
    v_add_f32 v44, v24, v26
    v_add_f32 v28, v28, v29
    v_add_f32 v30, v30, v31
    v_add_f32 v45, v28, v30
    v_fma_f32 v42, -v40, v44, v42
    v_fma_f32 v43, -v40, v45, v43
    v_mul_f32 v42, v41, v42
    v_mul_f32 v43, v41, v43
    v_cvt_pk_bf16_f32 v94, v42, v43
Lsk_7:
    v_bfe_u32 v56, v1, 3, 1
    v_lshlrev_b32 v56, 9, v56
    v_lshrrev_b32 v57, 4, v1
    v_lshl_add_u32 v93, v57, 4, v56
    v_and_b32 v56, 1, v1
    v_lshl_add_u32 v93, v56, 6, v93
    s_lshl_b32 s88, s75, 10
    s_add_u32 s88, s88, s93
    s_add_u32 s88, s88, 16384
    s_mov_b32 s92, s88
    s_add_u32 m0, s56, 4864
    s_nop 0
    buffer_load_dwordx4 v6, s[4:7], s53 offen offset:1280 nt lds
    s_add_u32 m0, s56, 5760
    s_nop 0
    buffer_load_dwordx4 v6, s[4:7], s53 offen offset:1408 nt lds
    s_add_u32 m0, s56, 8192
    s_nop 0
    buffer_load_dwordx4 v6, s[4:7], s54 offen offset:0 nt lds
    s_add_u32 m0, s56, 9088
    s_nop 0
    buffer_load_dwordx4 v6, s[4:7], s54 offen offset:128 nt lds
    s_cmp_eq_u32 s57, 3
    s_cbranch_scc1 Lsd_9
    s_branch Lsl_8
Lsd_9:
    s_cmp_eq_u32 s72, 0
    s_cbranch_scc1 Lsl_8
    s_mov_b64 exec, 0
    s_mov_b64 s[60:61], 0
    s_mov_b32 s62, 0
    s_getpc_b64 s[64:65]
Lpc_0:
    s_add_u32 s64, s64, Lsl_8-Lpc_0
    s_addc_u32 s65, s65, 0
    s_cmp_eq_u32 s72, 1
    s_cbranch_scc1 L_att
    s_cmp_eq_u32 s72, 2
    s_cbranch_scc1 Lseg_32
    s_branch Lseg_33
Lsl_8:
    s_waitcnt vmcnt(10)
    s_add_u32 m0, s56, 9984
    s_nop 0
    buffer_load_dwordx4 v6, s[4:7], s54 offen offset:256 nt lds
    s_add_u32 m0, s56, 10880
    s_nop 0
    buffer_load_dwordx4 v6, s[4:7], s54 offen offset:384 nt lds
    s_waitcnt vmcnt(10)
    s_add_u32 m0, s56, 11264
    s_nop 0
    buffer_load_dwordx4 v6, s[4:7], s54 offen offset:1024 nt lds
    s_add_u32 m0, s56, 12160
    s_nop 0
    buffer_load_dwordx4 v6, s[4:7], s54 offen offset:1152 nt lds
    s_waitcnt vmcnt(10)
    s_add_u32 m0, s56, 13056
    s_nop 0
    buffer_load_dwordx4 v6, s[4:7], s54 offen offset:1280 nt lds
    s_add_u32 m0, s56, 13952
    s_nop 0
    buffer_load_dwordx4 v6, s[4:7], s54 offen offset:1408 nt lds
    s_waitcnt vmcnt(10)
    s_add_u32 m0, s56, 16384
    s_nop 0
    buffer_load_dwordx4 v6, s[4:7], s55 offen offset:0 nt lds
    s_add_u32 m0, s56, 17280
    s_nop 0
    buffer_load_dwordx4 v6, s[4:7], s55 offen offset:128 nt lds
    s_cmp_eq_u32 s57, 3
    s_cbranch_scc1 Lsd_11
    s_branch Lsl_10
Lsd_11:
    s_cmp_eq_u32 s72, 0
    s_cbranch_scc1 Lsl_10
    s_mov_b64 exec, 0
    s_mov_b64 s[60:61], 0
    s_mov_b32 s62, 0
    s_getpc_b64 s[64:65]
Lpc_1:
    s_add_u32 s64, s64, Lsl_10-Lpc_1
    s_addc_u32 s65, s65, 0
    s_cmp_eq_u32 s72, 1
    s_cbranch_scc1 Lseg_34
    s_cmp_eq_u32 s72, 2
    s_cbranch_scc1 L_pv2
    s_branch Lseg_35
Lsl_10:
    s_waitcnt vmcnt(10)
    s_add_u32 m0, s56, 18176
    s_nop 0
    buffer_load_dwordx4 v6, s[4:7], s55 offen offset:256 nt lds
    s_add_u32 m0, s56, 19072
    s_nop 0
    buffer_load_dwordx4 v6, s[4:7], s55 offen offset:384 nt lds
    s_waitcnt vmcnt(10)
    s_add_u32 m0, s56, 19456
    s_nop 0
    buffer_load_dwordx4 v6, s[4:7], s55 offen offset:1024 nt lds
    s_add_u32 m0, s56, 20352
    s_nop 0
    buffer_load_dwordx4 v6, s[4:7], s55 offen offset:1152 nt lds
    s_waitcnt vmcnt(10)
    s_add_u32 m0, s56, 21248
    s_nop 0
    buffer_load_dwordx4 v6, s[4:7], s55 offen offset:1280 nt lds
    s_add_u32 m0, s56, 22144
    s_nop 0
    buffer_load_dwordx4 v6, s[4:7], s55 offen offset:1408 nt lds
    s_waitcnt vmcnt(10)
    buffer_load_dwordx4 a[0:3], v7, s[8:11], s48 offen offset:0 nt
    buffer_load_dwordx4 a[4:7], v7, s[8:11], s48 offen offset:256 nt
    s_cmp_eq_u32 s57, 3
    s_cbranch_scc1 Lsd_13
    s_call_b64 s[58:59], L_slot
    s_branch Lsl_12
Lsd_13:
    s_cmp_eq_u32 s72, 0
    s_cbranch_scc1 Lsl_12
    s_mov_b64 exec, 0
    s_mov_b64 s[60:61], 0
    s_mov_b32 s62, 0
    s_getpc_b64 s[64:65]
Lpc_2:
    s_add_u32 s64, s64, Lsl_12-Lpc_2
    s_addc_u32 s65, s65, 0
    s_cmp_eq_u32 s72, 1
    s_cbranch_scc1 Lseg_38
    s_cmp_eq_u32 s72, 2
    s_cbranch_scc1 Lseg_44
    s_branch Lseg_50
Lsl_12:
    s_waitcnt vmcnt(10)
    buffer_load_dwordx4 a[8:11], v7, s[8:11], s48 offen offset:512 nt
    buffer_load_dwordx4 a[12:15], v7, s[8:11], s48 offen offset:768 nt
    s_waitcnt vmcnt(10)
    buffer_load_dwordx4 a[16:19], v7, s[8:11], s48 offen offset:1024 nt
    buffer_load_dwordx4 a[20:23], v7, s[8:11], s48 offen offset:1280 nt
    s_waitcnt vmcnt(10)
    buffer_load_dwordx4 a[24:27], v7, s[8:11], s48 offen offset:1536 nt
    buffer_load_dwordx4 a[28:31], v7, s[8:11], s48 offen offset:1792 nt
    s_waitcnt vmcnt(10)
    buffer_load_dwordx4 a[32:35], v7, s[8:11], s49 offen offset:0 nt
    buffer_load_dwordx4 a[36:39], v7, s[8:11], s49 offen offset:256 nt
    s_cmp_eq_u32 s57, 3
    s_cbranch_scc1 Lsd_15
    s_waitcnt vmcnt(8)
    s_call_b64 s[58:59], L_slot
    s_branch Lsl_14
Lsd_15:
    s_cmp_eq_u32 s72, 0
    s_cbranch_scc1 Lsl_14
    s_mov_b64 exec, 0
    s_mov_b64 s[60:61], 0
    s_mov_b32 s62, 0
    s_getpc_b64 s[64:65]
Lpc_3:
    s_add_u32 s64, s64, Lsl_14-Lpc_3
    s_addc_u32 s65, s65, 0
    s_cmp_eq_u32 s72, 1
    s_cbranch_scc1 Lseg_53
    s_cmp_eq_u32 s72, 2
    s_cbranch_scc1 Lseg_59
    s_branch Lseg_65
Lsl_14:
    s_waitcnt vmcnt(10)
    buffer_load_dwordx4 a[40:43], v7, s[8:11], s49 offen offset:512 nt
    buffer_load_dwordx4 a[44:47], v7, s[8:11], s49 offen offset:768 nt
    s_waitcnt vmcnt(10)
    buffer_load_dwordx4 a[48:51], v7, s[8:11], s49 offen offset:1024 nt
    buffer_load_dwordx4 a[52:55], v7, s[8:11], s49 offen offset:1280 nt
    s_waitcnt vmcnt(10)
    buffer_load_dwordx4 a[56:59], v7, s[8:11], s49 offen offset:1536 nt
    buffer_load_dwordx4 a[60:63], v7, s[8:11], s49 offen offset:1792 nt
    s_waitcnt vmcnt(10)
    buffer_load_dwordx4 a[64:67], v7, s[8:11], s50 offen offset:0 nt
    buffer_load_dwordx4 a[68:71], v7, s[8:11], s50 offen offset:256 nt
    s_cmp_eq_u32 s57, 3
    s_cbranch_scc1 Lsd_17
    s_waitcnt vmcnt(8)
    s_call_b64 s[58:59], L_slot
    s_branch Lsl_16
Lsd_17:
    s_cmp_eq_u32 s72, 0
    s_cbranch_scc1 Lsl_16
    s_mov_b64 exec, 0
    s_mov_b64 s[60:61], 0
    s_mov_b32 s62, 0
    s_getpc_b64 s[64:65]
Lpc_4:
    s_add_u32 s64, s64, Lsl_16-Lpc_4
    s_addc_u32 s65, s65, 0
    s_cmp_eq_u32 s72, 1
    s_cbranch_scc1 Lseg_72
    s_cmp_eq_u32 s72, 2
    s_cbranch_scc1 Lseg_75
    s_branch Lseg_81
Lsl_16:
    s_waitcnt vmcnt(10)
    buffer_load_dwordx4 a[72:75], v7, s[8:11], s50 offen offset:512 nt
    buffer_load_dwordx4 a[76:79], v7, s[8:11], s50 offen offset:768 nt
    s_waitcnt vmcnt(10)
    buffer_load_dwordx4 a[80:83], v7, s[8:11], s50 offen offset:1024 nt
    buffer_load_dwordx4 a[84:87], v7, s[8:11], s50 offen offset:1280 nt
    s_waitcnt vmcnt(10)
    buffer_load_dwordx4 a[88:91], v7, s[8:11], s50 offen offset:1536 nt
    buffer_load_dwordx4 a[92:95], v7, s[8:11], s50 offen offset:1792 nt
    s_waitcnt vmcnt(10)
    buffer_load_dwordx4 a[96:99], v7, s[8:11], s51 offen offset:0 nt
    buffer_load_dwordx4 a[100:103], v7, s[8:11], s51 offen offset:256 nt
    s_cmp_eq_u32 s57, 3
    s_cbranch_scc1 Lsd_19
    s_waitcnt vmcnt(8)
    s_call_b64 s[58:59], L_slot
    s_branch Lsl_18
Lsd_19:
    s_cmp_eq_u32 s72, 0
    s_cbranch_scc1 Lsl_18
    s_mov_b64 exec, 0
    s_mov_b64 s[60:61], 0
    s_mov_b32 s62, 0
    s_getpc_b64 s[64:65]
Lpc_5:
    s_add_u32 s64, s64, Lsl_18-Lpc_5
    s_addc_u32 s65, s65, 0
    s_cmp_eq_u32 s72, 1
    s_cbranch_scc1 Lseg_87
    s_cmp_eq_u32 s72, 2
    s_cbranch_scc1 Lseg_96
    s_branch L_final
Lsl_18:
    s_waitcnt vmcnt(10)
    buffer_load_dwordx4 a[104:107], v7, s[8:11], s51 offen offset:512 nt
    buffer_load_dwordx4 a[108:111], v7, s[8:11], s51 offen offset:768 nt
    s_waitcnt vmcnt(10)
    buffer_load_dwordx4 a[112:115], v7, s[8:11], s51 offen offset:1024 nt
    buffer_load_dwordx4 a[116:119], v7, s[8:11], s51 offen offset:1280 nt
    s_waitcnt vmcnt(10)
    buffer_load_dwordx4 a[120:123], v7, s[8:11], s51 offen offset:1536 nt
    buffer_load_dwordx4 a[124:127], v7, s[8:11], s51 offen offset:1792 nt
    s_waitcnt vmcnt(10)
    buffer_load_dwordx4 a[128:131], v7, s[8:11], s52 offen offset:0 nt
    buffer_load_dwordx4 a[132:135], v7, s[8:11], s52 offen offset:256 nt
    s_cmp_eq_u32 s57, 3
    s_cbranch_scc1 Lsd_21
    s_waitcnt vmcnt(8)
    s_call_b64 s[58:59], L_slot
    s_branch Lsl_20
Lsd_21:
Lsl_20:
    s_lshl_b32 s77, s72, 11
    s_add_u32 s77, s77, s87
    s_add_u32 s77, s77, 4096
    v_mov_b32 v88, -1
    v_mov_b32 v89, -1
    v_mov_b32 v90, -1
    v_mov_b32 v91, -1
    s_cbranch_execz Ld_22
    buffer_store_dwordx4 v[88:91], v8, s[12:15], s77 offen
    s_cmp_eq_u32 s72, 3
    s_cbranch_scc1 Lrp_23
    buffer_store_dwordx4 v[88:91], v8, s[12:15], s77 offen offset:1024
Lrp_23:
Ld_22:
    buffer_load_dwordx4 v[76:79], v8, s[12:15], s77 offen offset:0 nt
    buffer_load_dwordx4 v[76:79], v8, s[12:15], s77 offen offset:1024 nt
    s_waitcnt vmcnt(13)
    buffer_load_dwordx4 a[136:139], v7, s[8:11], s52 offen offset:512 nt
    buffer_load_dwordx4 a[140:143], v7, s[8:11], s52 offen offset:768 nt
    s_waitcnt vmcnt(13)
    buffer_load_dwordx4 a[144:147], v7, s[8:11], s52 offen offset:1024 nt
    buffer_load_dwordx4 a[148:151], v7, s[8:11], s52 offen offset:1280 nt
    s_waitcnt vmcnt(13)
    buffer_load_dwordx4 a[152:155], v7, s[8:11], s52 offen offset:1536 nt
    buffer_load_dwordx4 a[156:159], v7, s[8:11], s52 offen offset:1792 nt
    s_waitcnt vmcnt(13)
    buffer_load_dwordx4 a[160:163], v7, s[8:11], s53 offen offset:0 nt
    buffer_load_dwordx4 a[164:167], v7, s[8:11], s53 offen offset:256 nt
    s_cmp_eq_u32 s57, 3
    s_cbranch_scc1 Lsd_25
    s_waitcnt vmcnt(11)
    s_call_b64 s[58:59], L_slot
    s_branch Lsl_24
Lsd_25:
Lsl_24:
    s_waitcnt vmcnt(13)
    buffer_load_dwordx4 a[168:171], v7, s[8:11], s53 offen offset:512 nt
    buffer_load_dwordx4 a[172:175], v7, s[8:11], s53 offen offset:768 nt
    s_waitcnt vmcnt(13)
    buffer_load_dwordx4 a[176:179], v7, s[8:11], s53 offen offset:1024 nt
    buffer_load_dwordx4 a[180:183], v7, s[8:11], s53 offen offset:1280 nt
    s_waitcnt vmcnt(10)
    buffer_load_dwordx4 a[184:187], v7, s[8:11], s53 offen offset:1536 nt
    buffer_load_dwordx4 a[188:191], v7, s[8:11], s53 offen offset:1792 nt
    s_cmp_eq_u32 s57, 3
    s_cbranch_scc1 Lsd_27
    s_waitcnt vmcnt(6)
    s_call_b64 s[58:59], L_slot
Lsd_27:
Lsl_26:
Lw_28:
    s_cmp_eq_u32 s57, 3
    s_cbranch_scc1 Lwd_29
    s_sub_u32 s79, s79, 1
    s_cbranch_scc1 L_end
    s_waitcnt vmcnt(0)
    s_call_b64 s[58:59], L_slot
    s_branch Lw_28
Lwd_29:
    s_waitcnt lgkmcnt(0)
    s_barrier
    ds_read_b128 v[16:19], v93 offset:9216
    ds_read_b128 v[20:23], v93 offset:9344
    ds_read_b128 v[24:27], v93 offset:9472
    ds_read_b128 v[28:31], v93 offset:9600
    s_waitcnt vmcnt(14)
    buffer_load_dwordx4 a[192:195], v7, s[8:11], s54 offen offset:0 nt
    buffer_load_dwordx4 a[196:199], v7, s[8:11], s54 offen offset:256 nt
    buffer_load_dwordx4 a[200:203], v7, s[8:11], s54 offen offset:512 nt
    buffer_load_dwordx4 a[204:207], v7, s[8:11], s54 offen offset:768 nt
    s_waitcnt lgkmcnt(0)
    ds_read_b128 v[80:83], v92 offset:0
    ds_read_b128 v[84:87], v92 offset:4096
    ds_read_b128 v[88:91], v92 offset:1024
    s_branch L_att
L_rest:
    s_waitcnt vmcnt(10)
    buffer_load_dwordx4 a[208:211], v7, s[8:11], s54 offen offset:1024 nt
    buffer_load_dwordx4 a[212:215], v7, s[8:11], s54 offen offset:1280 nt
    s_waitcnt vmcnt(10)
    buffer_load_dwordx4 a[216:219], v7, s[8:11], s54 offen offset:1536 nt
    buffer_load_dwordx4 a[220:223], v7, s[8:11], s54 offen offset:1792 nt
    s_waitcnt vmcnt(10)
    buffer_load_dwordx4 a[224:227], v7, s[8:11], s55 offen offset:0 nt
    buffer_load_dwordx4 a[228:231], v7, s[8:11], s55 offen offset:256 nt
    s_waitcnt vmcnt(10)
    buffer_load_dwordx4 a[232:235], v7, s[8:11], s55 offen offset:512 nt
    buffer_load_dwordx4 a[236:239], v7, s[8:11], s55 offen offset:768 nt
    s_waitcnt vmcnt(10)
    buffer_load_dwordx4 a[240:243], v7, s[8:11], s55 offen offset:1024 nt
    buffer_load_dwordx4 a[244:247], v7, s[8:11], s55 offen offset:1280 nt
    s_waitcnt vmcnt(10)
    buffer_load_dwordx4 a[248:251], v7, s[8:11], s55 offen offset:1536 nt
    buffer_load_dwordx4 a[252:255], v7, s[8:11], s55 offen offset:1792 nt
    s_and_b32 s77, s72, 1
    s_lshl_b32 s77, s77, 3
    s_lshl_b32 s78, s74, 4
    s_add_u32 s77, s77, s78
    v_lshrrev_b32 v18, 3, v1
    v_add_u32 v18, s77, v18
    v_mul_u32_u24 v18, 3584, v18
    v_and_b32 v19, 7, v1
    v_lshlrev_b32 v19, 6, v19
    v_min_u32 v19, 444, v19
    v_add_u32 v18, v18, v19
    s_mul_i32 s89, s73, 448
    s_cmp_ge_u32 s72, 2
    s_cbranch_scc1 Lt_30
    buffer_load_dword v94, v18, s[28:31], s89 offen
    s_branch Lt_31
Lt_30:
    buffer_load_dword v94, v18, s[32:35], s89 offen
Lt_31:
    v_and_b32 v93, 15, v1
    s_lshl_b32 s77, s72, 8
    v_lshrrev_b32 v18, 4, v1
    s_lshl_b32 s78, s97, 3
    v_add_u32 v18, s78, v18
    v_mul_u32_u24 v19, 896, v18
    v_lshl_add_u32 v19, v93, 4, v19
    s_lshl_b32 s88, s72, 11
    s_add_u32 m0, s88, 57344
    s_add_u32 s89, s77, 0
    buffer_load_dwordx4 v19, s[36:39], s89 offen nt lds
    s_add_u32 m0, s88, 58368
    s_add_u32 s89, s77, 3584
    buffer_load_dwordx4 v19, s[36:39], s89 offen nt lds
    s_branch L_pv2
L_att:
    s_mov_b32 vcc_lo, 0xaaaaaaaa
    s_mov_b32 vcc_hi, 0xaaaaaaaa
    v_mfma_f32_16x16x32_bf16 v[32:35], v[96:99], v[16:19], 0
    s_waitcnt lgkmcnt(2)
    v_mfma_f32_16x16x32_bf16 v[40:43], v[80:83], v[16:19], 0
    ds_read_b128 v[80:83], v92 offset:5120
    v_mfma_f32_16x16x32_bf16 v[36:39], v[112:115], v[16:19], 0
    s_waitcnt lgkmcnt(2)
    v_mfma_f32_16x16x32_bf16 v[44:47], v[84:87], v[16:19], 0
    ds_read_b128 v[84:87], v92 offset:2048
    v_mfma_f32_16x16x32_bf16 v[32:35], v[100:103], v[20:23], v[32:35]
    s_waitcnt lgkmcnt(2)
    v_mfma_f32_16x16x32_bf16 v[40:43], v[88:91], v[20:23], v[40:43]
    ds_read_b128 v[88:91], v92 offset:6144
    v_mfma_f32_16x16x32_bf16 v[36:39], v[116:119], v[20:23], v[36:39]
    s_waitcnt lgkmcnt(2)
    v_mfma_f32_16x16x32_bf16 v[44:47], v[80:83], v[20:23], v[44:47]
    ds_read_b128 v[80:83], v92 offset:3072
    v_mfma_f32_16x16x32_bf16 v[32:35], v[104:107], v[24:27], v[32:35]
    s_waitcnt lgkmcnt(2)
    v_mfma_f32_16x16x32_bf16 v[40:43], v[84:87], v[24:27], v[40:43]
    ds_read_b128 v[84:87], v92 offset:7168
    v_mfma_f32_16x16x32_bf16 v[36:39], v[120:123], v[24:27], v[36:39]
    s_waitcnt lgkmcnt(2)
    v_mfma_f32_16x16x32_bf16 v[44:47], v[88:91], v[24:27], v[44:47]
    ds_read_b128 v[88:91], v92 offset:8192
    v_mfma_f32_16x16x32_bf16 v[32:35], v[108:111], v[28:31], v[32:35]
    s_waitcnt lgkmcnt(2)
    v_mfma_f32_16x16x32_bf16 v[40:43], v[80:83], v[28:31], v[40:43]
    ds_read_b128 v[80:83], v92 offset:12288
    v_mfma_f32_16x16x32_bf16 v[36:39], v[124:127], v[28:31], v[36:39]
    s_waitcnt lgkmcnt(2)
    v_mfma_f32_16x16x32_bf16 v[44:47], v[84:87], v[28:31], v[44:47]
    ds_read_b128 v[84:87], v92 offset:9216
    s_nop 7
    v_cndmask_b32 v48, v32, v33, vcc
    v_cndmask_b32 v49, v34, v35, vcc
    v_cndmask_b32 v50, v36, v37, vcc
    v_cndmask_b32 v51, v38, v39, vcc
    v_add_f32_dpp v48, v48, v48 quad_perm:[1,0,3,2] row_mask:0xf bank_mask:0xf
    v_add_f32_dpp v49, v49, v49 quad_perm:[1,0,3,2] row_mask:0xf bank_mask:0xf
    v_add_f32_dpp v50, v50, v50 quad_perm:[1,0,3,2] row_mask:0xf bank_mask:0xf
    v_add_f32_dpp v51, v51, v51 quad_perm:[1,0,3,2] row_mask:0xf bank_mask:0xf
    s_nop 1
    v_cndmask_b32 v68, v40, v41, vcc
    v_cndmask_b32 v69, v42, v43, vcc
    v_cndmask_b32 v70, v44, v45, vcc
    v_cndmask_b32 v71, v46, v47, vcc
    v_add_f32_dpp v68, v68, v68 quad_perm:[1,0,3,2] row_mask:0xf bank_mask:0xf
    v_add_f32_dpp v69, v69, v69 quad_perm:[1,0,3,2] row_mask:0xf bank_mask:0xf
    v_add_f32_dpp v70, v70, v70 quad_perm:[1,0,3,2] row_mask:0xf bank_mask:0xf
    v_add_f32_dpp v71, v71, v71 quad_perm:[1,0,3,2] row_mask:0xf bank_mask:0xf
    v_mfma_f32_16x16x32_bf16 v[32:35], v[128:131], v[16:19], 0
    s_waitcnt lgkmcnt(2)
    v_mfma_f32_16x16x32_bf16 v[40:43], v[88:91], v[16:19], 0
    ds_read_b128 v[88:91], v92 offset:13312
    v_mfma_f32_16x16x32_bf16 v[36:39], v[144:147], v[16:19], 0
    s_waitcnt lgkmcnt(2)
    v_mfma_f32_16x16x32_bf16 v[44:47], v[80:83], v[16:19], 0
    ds_read_b128 v[80:83], v92 offset:10240
    v_mfma_f32_16x16x32_bf16 v[32:35], v[132:135], v[20:23], v[32:35]
    s_waitcnt lgkmcnt(2)
    v_mfma_f32_16x16x32_bf16 v[40:43], v[84:87], v[20:23], v[40:43]
    ds_read_b128 v[84:87], v92 offset:14336
    v_mfma_f32_16x16x32_bf16 v[36:39], v[148:151], v[20:23], v[36:39]
    s_waitcnt lgkmcnt(2)
    v_mfma_f32_16x16x32_bf16 v[44:47], v[88:91], v[20:23], v[44:47]
    ds_read_b128 v[88:91], v92 offset:11264
    v_mfma_f32_16x16x32_bf16 v[32:35], v[136:139], v[24:27], v[32:35]
    s_waitcnt lgkmcnt(2)
    v_mfma_f32_16x16x32_bf16 v[40:43], v[80:83], v[24:27], v[40:43]
    ds_read_b128 v[80:83], v92 offset:15360
    v_mfma_f32_16x16x32_bf16 v[36:39], v[152:155], v[24:27], v[36:39]
    s_waitcnt lgkmcnt(2)
    v_mfma_f32_16x16x32_bf16 v[44:47], v[84:87], v[24:27], v[44:47]
    ds_read_b128 v[84:87], v92 offset:16384
    v_mfma_f32_16x16x32_bf16 v[32:35], v[140:143], v[28:31], v[32:35]
    s_waitcnt lgkmcnt(2)
    v_mfma_f32_16x16x32_bf16 v[40:43], v[88:91], v[28:31], v[40:43]
    ds_read_b128 v[88:91], v92 offset:20480
    v_mfma_f32_16x16x32_bf16 v[36:39], v[156:159], v[28:31], v[36:39]
    s_waitcnt lgkmcnt(2)
    v_mfma_f32_16x16x32_bf16 v[44:47], v[80:83], v[28:31], v[44:47]
    ds_read_b128 v[80:83], v92 offset:17408
    s_nop 7
    v_cndmask_b32 v52, v32, v33, vcc
    v_cndmask_b32 v53, v34, v35, vcc
    v_cndmask_b32 v54, v36, v37, vcc
    v_cndmask_b32 v55, v38, v39, vcc
    v_add_f32_dpp v52, v52, v52 quad_perm:[1,0,3,2] row_mask:0xf bank_mask:0xf
    v_add_f32_dpp v53, v53, v53 quad_perm:[1,0,3,2] row_mask:0xf bank_mask:0xf
    v_add_f32_dpp v54, v54, v54 quad_perm:[1,0,3,2] row_mask:0xf bank_mask:0xf
    v_add_f32_dpp v55, v55, v55 quad_perm:[1,0,3,2] row_mask:0xf bank_mask:0xf
    s_nop 1
    v_cndmask_b32 v72, v40, v41, vcc
    v_cndmask_b32 v73, v42, v43, vcc
    v_cndmask_b32 v74, v44, v45, vcc
    v_cndmask_b32 v75, v46, v47, vcc
    v_add_f32_dpp v72, v72, v72 quad_perm:[1,0,3,2] row_mask:0xf bank_mask:0xf
    v_add_f32_dpp v73, v73, v73 quad_perm:[1,0,3,2] row_mask:0xf bank_mask:0xf
    v_add_f32_dpp v74, v74, v74 quad_perm:[1,0,3,2] row_mask:0xf bank_mask:0xf
    v_add_f32_dpp v75, v75, v75 quad_perm:[1,0,3,2] row_mask:0xf bank_mask:0xf
    s_cbranch_execz L_dryret
Lseg_32:
    v_mfma_f32_16x16x32_bf16 v[32:35], v[160:163], v[16:19], 0
    s_waitcnt lgkmcnt(2)
    v_mfma_f32_16x16x32_bf16 v[40:43], v[84:87], v[16:19], 0
    ds_read_b128 v[84:87], v92 offset:21504
    v_mfma_f32_16x16x32_bf16 v[36:39], v[176:179], v[16:19], 0
    s_waitcnt lgkmcnt(2)
    v_mfma_f32_16x16x32_bf16 v[44:47], v[88:91], v[16:19], 0
    ds_read_b128 v[88:91], v92 offset:18432
    v_mfma_f32_16x16x32_bf16 v[32:35], v[164:167], v[20:23], v[32:35]
    s_waitcnt lgkmcnt(2)
    v_mfma_f32_16x16x32_bf16 v[40:43], v[80:83], v[20:23], v[40:43]
    ds_read_b128 v[80:83], v92 offset:22528
    v_mfma_f32_16x16x32_bf16 v[36:39], v[180:183], v[20:23], v[36:39]
    s_waitcnt lgkmcnt(2)
    v_mfma_f32_16x16x32_bf16 v[44:47], v[84:87], v[20:23], v[44:47]
    ds_read_b128 v[84:87], v92 offset:19456
    v_mfma_f32_16x16x32_bf16 v[32:35], v[168:171], v[24:27], v[32:35]
    s_waitcnt lgkmcnt(2)
    v_mfma_f32_16x16x32_bf16 v[40:43], v[88:91], v[24:27], v[40:43]
    ds_read_b128 v[88:91], v92 offset:23552
    v_mfma_f32_16x16x32_bf16 v[36:39], v[184:187], v[24:27], v[36:39]
    s_waitcnt lgkmcnt(2)
    v_mfma_f32_16x16x32_bf16 v[44:47], v[80:83], v[24:27], v[44:47]
    v_mfma_f32_16x16x32_bf16 v[32:35], v[172:175], v[28:31], v[32:35]
    s_waitcnt lgkmcnt(1)
    v_mfma_f32_16x16x32_bf16 v[40:43], v[84:87], v[28:31], v[40:43]
    v_mfma_f32_16x16x32_bf16 v[36:39], v[188:191], v[28:31], v[36:39]
    s_waitcnt lgkmcnt(0)
    v_mfma_f32_16x16x32_bf16 v[44:47], v[88:91], v[28:31], v[44:47]
    s_nop 7
    v_cndmask_b32 v56, v32, v33, vcc
    v_cndmask_b32 v57, v34, v35, vcc
    v_cndmask_b32 v58, v36, v37, vcc
    v_cndmask_b32 v59, v38, v39, vcc
    v_add_f32_dpp v56, v56, v56 quad_perm:[1,0,3,2] row_mask:0xf bank_mask:0xf
    v_add_f32_dpp v57, v57, v57 quad_perm:[1,0,3,2] row_mask:0xf bank_mask:0xf
    v_add_f32_dpp v58, v58, v58 quad_perm:[1,0,3,2] row_mask:0xf bank_mask:0xf
    v_add_f32_dpp v59, v59, v59 quad_perm:[1,0,3,2] row_mask:0xf bank_mask:0xf
    s_nop 1
    v_cndmask_b32 v76, v40, v41, vcc
    v_cndmask_b32 v77, v42, v43, vcc
    v_cndmask_b32 v78, v44, v45, vcc
    v_cndmask_b32 v79, v46, v47, vcc
    v_add_f32_dpp v76, v76, v76 quad_perm:[1,0,3,2] row_mask:0xf bank_mask:0xf
    v_add_f32_dpp v77, v77, v77 quad_perm:[1,0,3,2] row_mask:0xf bank_mask:0xf
    v_add_f32_dpp v78, v78, v78 quad_perm:[1,0,3,2] row_mask:0xf bank_mask:0xf
    v_add_f32_dpp v79, v79, v79 quad_perm:[1,0,3,2] row_mask:0xf bank_mask:0xf
    v_mfma_f32_16x16x32_bf16 v[32:35], v[192:195], v[16:19], 0
    v_mfma_f32_16x16x32_bf16 v[40:43], v[224:227], v[16:19], 0
    v_mfma_f32_16x16x32_bf16 v[36:39], v[208:211], v[16:19], 0
    v_mfma_f32_16x16x32_bf16 v[44:47], v[240:243], v[16:19], 0
    v_mfma_f32_16x16x32_bf16 v[32:35], v[196:199], v[20:23], v[32:35]
    v_mfma_f32_16x16x32_bf16 v[40:43], v[228:231], v[20:23], v[40:43]
    v_mfma_f32_16x16x32_bf16 v[36:39], v[212:215], v[20:23], v[36:39]
    v_mfma_f32_16x16x32_bf16 v[44:47], v[244:247], v[20:23], v[44:47]
    v_mfma_f32_16x16x32_bf16 v[32:35], v[200:203], v[24:27], v[32:35]
    v_mfma_f32_16x16x32_bf16 v[40:43], v[232:235], v[24:27], v[40:43]
    v_mfma_f32_16x16x32_bf16 v[36:39], v[216:219], v[24:27], v[36:39]
    v_mfma_f32_16x16x32_bf16 v[44:47], v[248:251], v[24:27], v[44:47]
    v_mfma_f32_16x16x32_bf16 v[32:35], v[204:207], v[28:31], v[32:35]
    v_mfma_f32_16x16x32_bf16 v[40:43], v[236:239], v[28:31], v[40:43]
    v_mfma_f32_16x16x32_bf16 v[36:39], v[220:223], v[28:31], v[36:39]
    v_mfma_f32_16x16x32_bf16 v[44:47], v[252:255], v[28:31], v[44:47]
    s_nop 7
    v_cndmask_b32 v60, v32, v33, vcc
    v_cndmask_b32 v61, v34, v35, vcc
    v_cndmask_b32 v62, v36, v37, vcc
    v_cndmask_b32 v63, v38, v39, vcc
    v_add_f32_dpp v60, v60, v60 quad_perm:[1,0,3,2] row_mask:0xf bank_mask:0xf
    v_add_f32_dpp v61, v61, v61 quad_perm:[1,0,3,2] row_mask:0xf bank_mask:0xf
    v_add_f32_dpp v62, v62, v62 quad_perm:[1,0,3,2] row_mask:0xf bank_mask:0xf
    v_add_f32_dpp v63, v63, v63 quad_perm:[1,0,3,2] row_mask:0xf bank_mask:0xf
    s_nop 1
    v_cndmask_b32 v64, v40, v41, vcc
    v_cndmask_b32 v65, v42, v43, vcc
    v_cndmask_b32 v66, v44, v45, vcc
    v_cndmask_b32 v67, v46, v47, vcc
    v_add_f32_dpp v64, v64, v64 quad_perm:[1,0,3,2] row_mask:0xf bank_mask:0xf
    v_add_f32_dpp v65, v65, v65 quad_perm:[1,0,3,2] row_mask:0xf bank_mask:0xf
    v_add_f32_dpp v66, v66, v66 quad_perm:[1,0,3,2] row_mask:0xf bank_mask:0xf
    v_add_f32_dpp v67, v67, v67 quad_perm:[1,0,3,2] row_mask:0xf bank_mask:0xf
    s_cmp_eq_u32 s63, 0
    s_cbranch_scc1 L_nw
    s_waitcnt vmcnt(0)
L_nw:
    s_nop 0
    v_max3_f32 v16, v48, v49, v50
    v_max3_f32 v17, v51, v52, v53
    v_max3_f32 v16, v16, v54, v55
    v_max3_f32 v17, v17, v56, v57
    v_max3_f32 v16, v16, v58, v59
    v_max3_f32 v17, v17, v60, v61
    v_max3_f32 v16, v16, v62, v63
    v_max3_f32 v17, v17, v64, v65
    v_max3_f32 v16, v16, v66, v67
    v_max3_f32 v17, v17, v68, v69
    v_max3_f32 v16, v16, v70, v71
    v_max3_f32 v17, v17, v72, v73
    v_max3_f32 v16, v16, v74, v75
    v_max3_f32 v17, v17, v76, v77
    v_max3_f32 v16, v16, v78, v79
    v_max_f32 v16, v16, v17
    v_mov_b32 v17, v16
    s_nop 1
    v_permlane16_swap_b32 v16, v17
    s_nop 1
    v_max_f32 v16, v16, v17
    v_mov_b32 v17, v16
    s_nop 1
    v_permlane32_swap_b32 v16, v17
    s_nop 1
    v_max_f32 v16, v16, v17
    v_mul_f32 v16, s86, v16
    v_mov_b32 v17, 0
    s_cbranch_execz L_dryret
Lseg_33:
    v_fma_f32 v48, v48, s86, -v16
    v_fma_f32 v49, v49, s86, -v16
    v_fma_f32 v50, v50, s86, -v16
    v_fma_f32 v51, v51, s86, -v16
    v_exp_f32 v48, v48
    v_exp_f32 v49, v49
    v_exp_f32 v50, v50
    v_exp_f32 v51, v51
    v_add_f32 v17, v17, v48
    v_cvt_pk_bf16_f32 v48, v48, v48
    v_add_f32 v17, v17, v49
    v_cvt_pk_bf16_f32 v49, v49, v49
    v_add_f32 v17, v17, v50
    v_cvt_pk_bf16_f32 v50, v50, v50
    v_add_f32 v17, v17, v51
    v_cvt_pk_bf16_f32 v51, v51, v51
    v_and_b32 v24, v48, v2
    v_and_b32 v25, v48, v3
    v_and_b32 v26, v48, v4
    v_and_b32 v27, v48, v5
    v_and_b32 v28, v49, v2
    v_and_b32 v29, v49, v3
    v_and_b32 v30, v49, v4
    v_and_b32 v31, v49, v5
    v_and_b32 v32, v50, v2
    v_and_b32 v33, v50, v3
    v_and_b32 v34, v50, v4
    v_and_b32 v35, v50, v5
    v_and_b32 v36, v51, v2
    v_and_b32 v37, v51, v3
    v_and_b32 v38, v51, v4
    v_and_b32 v39, v51, v5
    s_nop 0
    v_mfma_f32_16x16x32_bf16 v[40:43], a[0:3], v[24:27], 0
    v_fma_f32 v52, v52, s86, -v16
    v_fma_f32 v53, v53, s86, -v16
    v_fma_f32 v54, v54, s86, -v16
    v_fma_f32 v55, v55, s86, -v16
    v_mfma_f32_16x16x32_bf16 v[44:47], a[4:7], v[24:27], 0
    v_exp_f32 v52, v52
    v_exp_f32 v53, v53
    v_exp_f32 v54, v54
    v_exp_f32 v55, v55
    v_mfma_f32_16x16x32_bf16 v[40:43], a[8:11], v[28:31], v[40:43]
    v_add_f32 v17, v17, v52
    v_cvt_pk_bf16_f32 v52, v52, v52
    v_add_f32 v17, v17, v53
    v_cvt_pk_bf16_f32 v53, v53, v53
    v_mfma_f32_16x16x32_bf16 v[44:47], a[12:15], v[28:31], v[44:47]
    v_add_f32 v17, v17, v54
    v_cvt_pk_bf16_f32 v54, v54, v54
    v_add_f32 v17, v17, v55
    v_cvt_pk_bf16_f32 v55, v55, v55
    v_mfma_f32_16x16x32_bf16 v[40:43], a[16:19], v[32:35], v[40:43]
    v_and_b32 v84, v52, v2
    v_and_b32 v85, v52, v3
    v_and_b32 v86, v52, v4
    v_and_b32 v87, v52, v5
    v_mfma_f32_16x16x32_bf16 v[44:47], a[20:23], v[32:35], v[44:47]
    v_and_b32 v88, v53, v2
    v_and_b32 v89, v53, v3
    v_and_b32 v90, v53, v4
    v_and_b32 v91, v53, v5
    v_mfma_f32_16x16x32_bf16 v[40:43], a[24:27], v[36:39], v[40:43]
    v_and_b32 v20, v54, v2
    v_and_b32 v21, v54, v3
    v_and_b32 v22, v54, v4
    v_and_b32 v23, v54, v5
    v_mfma_f32_16x16x32_bf16 v[44:47], a[28:31], v[36:39], v[44:47]
    v_and_b32 v80, v55, v2
    v_and_b32 v81, v55, v3
    v_and_b32 v82, v55, v4
    v_and_b32 v83, v55, v5
    s_nop 0
    v_mfma_f32_16x16x32_bf16 v[40:43], a[32:35], v[84:87], v[40:43]
    v_fma_f32 v56, v56, s86, -v16
    v_fma_f32 v57, v57, s86, -v16
    v_fma_f32 v58, v58, s86, -v16
    v_fma_f32 v59, v59, s86, -v16
    v_mfma_f32_16x16x32_bf16 v[44:47], a[36:39], v[84:87], v[44:47]
    v_exp_f32 v56, v56
    v_exp_f32 v57, v57
    v_exp_f32 v58, v58
    v_exp_f32 v59, v59
    v_mfma_f32_16x16x32_bf16 v[40:43], a[40:43], v[88:91], v[40:43]
    v_add_f32 v17, v17, v56
    v_cvt_pk_bf16_f32 v56, v56, v56
    v_add_f32 v17, v17, v57
    v_cvt_pk_bf16_f32 v57, v57, v57
    v_mfma_f32_16x16x32_bf16 v[44:47], a[44:47], v[88:91], v[44:47]
    v_add_f32 v17, v17, v58
    v_cvt_pk_bf16_f32 v58, v58, v58
    v_add_f32 v17, v17, v59
    v_cvt_pk_bf16_f32 v59, v59, v59
    v_mfma_f32_16x16x32_bf16 v[40:43], a[48:51], v[20:23], v[40:43]
    v_and_b32 v24, v56, v2
    v_and_b32 v25, v56, v3
    v_and_b32 v26, v56, v4
    v_and_b32 v27, v56, v5
    v_mfma_f32_16x16x32_bf16 v[44:47], a[52:55], v[20:23], v[44:47]
    v_and_b32 v28, v57, v2
    v_and_b32 v29, v57, v3
    v_and_b32 v30, v57, v4
    v_and_b32 v31, v57, v5
    v_mfma_f32_16x16x32_bf16 v[40:43], a[56:59], v[80:83], v[40:43]
    v_and_b32 v32, v58, v2
    v_and_b32 v33, v58, v3
    v_and_b32 v34, v58, v4
    v_and_b32 v35, v58, v5
    v_mfma_f32_16x16x32_bf16 v[44:47], a[60:63], v[80:83], v[44:47]
    v_and_b32 v36, v59, v2
    v_and_b32 v37, v59, v3
    v_and_b32 v38, v59, v4
    v_and_b32 v39, v59, v5
    s_cbranch_execz L_dryret
Lseg_34:
    s_nop 0
    v_mfma_f32_16x16x32_bf16 v[40:43], a[64:67], v[24:27], v[40:43]
    v_fma_f32 v60, v60, s86, -v16
    v_fma_f32 v61, v61, s86, -v16
    v_fma_f32 v62, v62, s86, -v16
    v_fma_f32 v63, v63, s86, -v16
    v_mfma_f32_16x16x32_bf16 v[44:47], a[68:71], v[24:27], v[44:47]
    v_exp_f32 v60, v60
    v_exp_f32 v61, v61
    v_exp_f32 v62, v62
    v_exp_f32 v63, v63
    v_mfma_f32_16x16x32_bf16 v[40:43], a[72:75], v[28:31], v[40:43]
    v_add_f32 v17, v17, v60
    v_cvt_pk_bf16_f32 v60, v60, v60
    v_add_f32 v17, v17, v61
    v_cvt_pk_bf16_f32 v61, v61, v61
    v_mfma_f32_16x16x32_bf16 v[44:47], a[76:79], v[28:31], v[44:47]
    v_add_f32 v17, v17, v62
    v_cvt_pk_bf16_f32 v62, v62, v62
    v_add_f32 v17, v17, v63
    v_cvt_pk_bf16_f32 v63, v63, v63
    v_mfma_f32_16x16x32_bf16 v[40:43], a[80:83], v[32:35], v[40:43]
    v_and_b32 v84, v60, v2
    v_and_b32 v85, v60, v3
    v_and_b32 v86, v60, v4
    v_and_b32 v87, v60, v5
    v_mfma_f32_16x16x32_bf16 v[44:47], a[84:87], v[32:35], v[44:47]
    v_and_b32 v88, v61, v2
    v_and_b32 v89, v61, v3
    v_and_b32 v90, v61, v4
    v_and_b32 v91, v61, v5
    v_mfma_f32_16x16x32_bf16 v[40:43], a[88:91], v[36:39], v[40:43]
    v_and_b32 v20, v62, v2
    v_and_b32 v21, v62, v3
    v_and_b32 v22, v62, v4
    v_and_b32 v23, v62, v5
    v_mfma_f32_16x16x32_bf16 v[44:47], a[92:95], v[36:39], v[44:47]
    v_and_b32 v80, v63, v2
    v_and_b32 v81, v63, v3
    v_and_b32 v82, v63, v4
    v_and_b32 v83, v63, v5
    s_nop 0
    v_mfma_f32_16x16x32_bf16 v[40:43], a[96:99], v[84:87], v[40:43]
    v_fma_f32 v64, v64, s86, -v16
    v_fma_f32 v65, v65, s86, -v16
    v_fma_f32 v66, v66, s86, -v16
    v_fma_f32 v67, v67, s86, -v16
    v_mfma_f32_16x16x32_bf16 v[44:47], a[100:103], v[84:87], v[44:47]
    v_exp_f32 v64, v64
    v_exp_f32 v65, v65
    v_exp_f32 v66, v66
    v_exp_f32 v67, v67
    v_mfma_f32_16x16x32_bf16 v[40:43], a[104:107], v[88:91], v[40:43]
    v_add_f32 v17, v17, v64
    v_cvt_pk_bf16_f32 v64, v64, v64
    v_add_f32 v17, v17, v65
    v_cvt_pk_bf16_f32 v65, v65, v65
    v_mfma_f32_16x16x32_bf16 v[44:47], a[108:111], v[88:91], v[44:47]
    v_add_f32 v17, v17, v66
    v_cvt_pk_bf16_f32 v66, v66, v66
    v_add_f32 v17, v17, v67
    v_cvt_pk_bf16_f32 v67, v67, v67
    v_mfma_f32_16x16x32_bf16 v[40:43], a[112:115], v[20:23], v[40:43]
    v_and_b32 v24, v64, v2
    v_and_b32 v25, v64, v3
    v_and_b32 v26, v64, v4
    v_and_b32 v27, v64, v5
    v_mfma_f32_16x16x32_bf16 v[44:47], a[116:119], v[20:23], v[44:47]
    v_and_b32 v28, v65, v2
    v_and_b32 v29, v65, v3
    v_and_b32 v30, v65, v4
    v_and_b32 v31, v65, v5
    v_mfma_f32_16x16x32_bf16 v[40:43], a[120:123], v[80:83], v[40:43]
    v_and_b32 v32, v66, v2
    v_and_b32 v33, v66, v3
    v_and_b32 v34, v66, v4
    v_and_b32 v35, v66, v5
    v_mfma_f32_16x16x32_bf16 v[44:47], a[124:127], v[80:83], v[44:47]
    v_and_b32 v36, v67, v2
    v_and_b32 v37, v67, v3
    v_and_b32 v38, v67, v4
    v_and_b32 v39, v67, v5
    s_cbranch_execz L_dryret
    s_cmp_eq_u32 s63, 0
    s_cbranch_scc1 L_rest
L_pv2:
    s_nop 0
    v_mfma_f32_16x16x32_bf16 v[40:43], a[128:131], v[24:27], v[40:43]
    v_fma_f32 v68, v68, s86, -v16
    v_fma_f32 v69, v69, s86, -v16
    v_fma_f32 v70, v70, s86, -v16
    v_fma_f32 v71, v71, s86, -v16
    v_mfma_f32_16x16x32_bf16 v[44:47], a[132:135], v[24:27], v[44:47]
    v_exp_f32 v68, v68
    v_exp_f32 v69, v69
    v_exp_f32 v70, v70
    v_exp_f32 v71, v71
    v_mfma_f32_16x16x32_bf16 v[40:43], a[136:139], v[28:31], v[40:43]
    v_add_f32 v17, v17, v68
    v_cvt_pk_bf16_f32 v68, v68, v68
    v_add_f32 v17, v17, v69
    v_cvt_pk_bf16_f32 v69, v69, v69
    v_mfma_f32_16x16x32_bf16 v[44:47], a[140:143], v[28:31], v[44:47]
    v_add_f32 v17, v17, v70
    v_cvt_pk_bf16_f32 v70, v70, v70
    v_add_f32 v17, v17, v71
    v_cvt_pk_bf16_f32 v71, v71, v71
    v_mfma_f32_16x16x32_bf16 v[40:43], a[144:147], v[32:35], v[40:43]
    v_and_b32 v84, v68, v2
    v_and_b32 v85, v68, v3
    v_and_b32 v86, v68, v4
    v_and_b32 v87, v68, v5
    v_mfma_f32_16x16x32_bf16 v[44:47], a[148:151], v[32:35], v[44:47]
    v_and_b32 v88, v69, v2
    v_and_b32 v89, v69, v3
    v_and_b32 v90, v69, v4
    v_and_b32 v91, v69, v5
    v_mfma_f32_16x16x32_bf16 v[40:43], a[152:155], v[36:39], v[40:43]
    v_and_b32 v20, v70, v2
    v_and_b32 v21, v70, v3
    v_and_b32 v22, v70, v4
    v_and_b32 v23, v70, v5
    v_mfma_f32_16x16x32_bf16 v[44:47], a[156:159], v[36:39], v[44:47]
    v_and_b32 v80, v71, v2
    v_and_b32 v81, v71, v3
    v_and_b32 v82, v71, v4
    v_and_b32 v83, v71, v5
    s_nop 0
    v_mfma_f32_16x16x32_bf16 v[40:43], a[160:163], v[84:87], v[40:43]
    v_fma_f32 v72, v72, s86, -v16
    v_fma_f32 v73, v73, s86, -v16
    v_fma_f32 v74, v74, s86, -v16
    v_fma_f32 v75, v75, s86, -v16
    v_mfma_f32_16x16x32_bf16 v[44:47], a[164:167], v[84:87], v[44:47]
    v_exp_f32 v72, v72
    v_exp_f32 v73, v73
    v_exp_f32 v74, v74
    v_exp_f32 v75, v75
    v_mfma_f32_16x16x32_bf16 v[40:43], a[168:171], v[88:91], v[40:43]
    v_add_f32 v17, v17, v72
    v_cvt_pk_bf16_f32 v72, v72, v72
    v_add_f32 v17, v17, v73
    v_cvt_pk_bf16_f32 v73, v73, v73
    v_mfma_f32_16x16x32_bf16 v[44:47], a[172:175], v[88:91], v[44:47]
    v_add_f32 v17, v17, v74
    v_cvt_pk_bf16_f32 v74, v74, v74
    v_add_f32 v17, v17, v75
    v_cvt_pk_bf16_f32 v75, v75, v75
    v_mfma_f32_16x16x32_bf16 v[40:43], a[176:179], v[20:23], v[40:43]
    v_and_b32 v24, v72, v2
    v_and_b32 v25, v72, v3
    v_and_b32 v26, v72, v4
    v_and_b32 v27, v72, v5
    v_mfma_f32_16x16x32_bf16 v[44:47], a[180:183], v[20:23], v[44:47]
    v_and_b32 v28, v73, v2
    v_and_b32 v29, v73, v3
    v_and_b32 v30, v73, v4
    v_and_b32 v31, v73, v5
    v_mfma_f32_16x16x32_bf16 v[40:43], a[184:187], v[80:83], v[40:43]
    v_and_b32 v32, v74, v2
    v_and_b32 v33, v74, v3
    v_and_b32 v34, v74, v4
    v_and_b32 v35, v74, v5
    v_mfma_f32_16x16x32_bf16 v[44:47], a[188:191], v[80:83], v[44:47]
    v_and_b32 v36, v75, v2
    v_and_b32 v37, v75, v3
    v_and_b32 v38, v75, v4
    v_and_b32 v39, v75, v5
    s_cbranch_execz L_dryret
Lseg_35:
    s_cbranch_execz Ld_36
    s_waitcnt vmcnt(11)
Ld_36:
    s_nop 0
    v_mfma_f32_16x16x32_bf16 v[40:43], a[192:195], v[24:27], v[40:43]
    v_fma_f32 v76, v76, s86, -v16
    v_fma_f32 v77, v77, s86, -v16
    v_fma_f32 v78, v78, s86, -v16
    v_fma_f32 v79, v79, s86, -v16
    v_mfma_f32_16x16x32_bf16 v[44:47], a[196:199], v[24:27], v[44:47]
    v_exp_f32 v76, v76
    v_exp_f32 v77, v77
    v_exp_f32 v78, v78
    v_exp_f32 v79, v79
    v_mfma_f32_16x16x32_bf16 v[40:43], a[200:203], v[28:31], v[40:43]
    v_add_f32 v17, v17, v76
    v_cvt_pk_bf16_f32 v76, v76, v76
    v_add_f32 v17, v17, v77
    v_cvt_pk_bf16_f32 v77, v77, v77
    v_mfma_f32_16x16x32_bf16 v[44:47], a[204:207], v[28:31], v[44:47]
    v_add_f32 v17, v17, v78
    v_cvt_pk_bf16_f32 v78, v78, v78
    v_add_f32 v17, v17, v79
    v_cvt_pk_bf16_f32 v79, v79, v79
    v_mfma_f32_16x16x32_bf16 v[40:43], a[208:211], v[32:35], v[40:43]
    v_and_b32 v84, v76, v2
    v_and_b32 v85, v76, v3
    v_and_b32 v86, v76, v4
    v_and_b32 v87, v76, v5
    v_mfma_f32_16x16x32_bf16 v[44:47], a[212:215], v[32:35], v[44:47]
    v_and_b32 v88, v77, v2
    v_and_b32 v89, v77, v3
    v_and_b32 v90, v77, v4
    v_and_b32 v91, v77, v5
    v_mfma_f32_16x16x32_bf16 v[40:43], a[216:219], v[36:39], v[40:43]
    v_and_b32 v20, v78, v2
    v_and_b32 v21, v78, v3
    v_and_b32 v22, v78, v4
    v_and_b32 v23, v78, v5
    v_mfma_f32_16x16x32_bf16 v[44:47], a[220:223], v[36:39], v[44:47]
    v_and_b32 v80, v79, v2
    v_and_b32 v81, v79, v3
    v_and_b32 v82, v79, v4
    v_and_b32 v83, v79, v5
    s_cbranch_execz Ld_37
    s_waitcnt vmcnt(3)
Ld_37:
    s_nop 0
    v_mfma_f32_16x16x32_bf16 v[40:43], a[224:227], v[84:87], v[40:43]
    v_mfma_f32_16x16x32_bf16 v[44:47], a[228:231], v[84:87], v[44:47]
    v_mfma_f32_16x16x32_bf16 v[40:43], a[232:235], v[88:91], v[40:43]
    v_mfma_f32_16x16x32_bf16 v[44:47], a[236:239], v[88:91], v[44:47]
    v_mfma_f32_16x16x32_bf16 v[40:43], a[240:243], v[20:23], v[40:43]
    v_mfma_f32_16x16x32_bf16 v[44:47], a[244:247], v[20:23], v[44:47]
    v_mfma_f32_16x16x32_bf16 v[40:43], a[248:251], v[80:83], v[40:43]
    v_mfma_f32_16x16x32_bf16 v[44:47], a[252:255], v[80:83], v[44:47]
    s_nop 7
    s_cbranch_execz L_dryret
Lseg_38:
    v_mov_b32 v18, v17
    s_nop 1
    v_permlane16_swap_b32 v17, v18
    s_nop 1
    v_add_f32 v17, v17, v18
    v_mov_b32 v18, v17
    s_nop 1
    v_permlane32_swap_b32 v17, v18
    s_nop 1
    v_add_f32 v17, v17, v18
    v_bfe_u32 v18, v1, 3, 1
    v_lshlrev_b32 v18, 5, v18
    s_lshl_b32 s77, s72, 3
    v_add_u32 v19, s77, v18
    s_lshl_b32 s77, s72, 11
    v_add_u32 v20, s77, v8
    s_and_b32 exec_lo, s60, 0x101
    s_and_b32 exec_hi, s60, 0x0
    ds_write_b64 v19, v[16:17] offset:8192
    s_mov_b64 exec, s[60:61]
    ds_write_b128 v20, v[40:43] offset:0
    ds_write_b128 v20, v[44:47] offset:1024
    s_waitcnt lgkmcnt(0)
    s_cbranch_execz Ld_39
    s_barrier
Ld_39:
    s_cmp_ge_u32 s62, 2
    s_cbranch_scc1 Lapk_40
    s_lshl_b32 s77, s72, 10
    v_add_u32 v20, s77, v8
    ds_read_b128 v[24:27], v18 offset:8192
    ds_read_b128 v[28:31], v18 offset:8208
    ds_read_b128 v[32:35], v20 offset:0
    ds_read_b128 v[36:39], v20 offset:2048
    ds_read_b128 v[40:43], v20 offset:4096
    ds_read_b128 v[44:47], v20 offset:6144
    s_waitcnt lgkmcnt(4)
    v_max3_f32 v21, v24, v26, v28
    v_max_f32 v21, v21, v30
    v_sub_f32 v24, v24, v21
    v_sub_f32 v26, v26, v21
    v_sub_f32 v28, v28, v21
    v_sub_f32 v30, v30, v21
    v_exp_f32 v24, v24
    v_exp_f32 v26, v26
    v_exp_f32 v28, v28
    v_exp_f32 v30, v30
    s_nop 0
    v_mul_f32 v22, v24, v25
    v_fma_f32 v22, v26, v27, v22
    v_fma_f32 v22, v28, v29, v22
    v_fma_f32 v22, v30, v31, v22
    v_rcp_f32 v23, v22
    v_log_f32 v22, v22
    s_nop 0
    v_add_f32 v22, v22, v21
    v_mul_f32 v24, v24, v23
    v_mul_f32 v26, v26, v23
    v_mul_f32 v28, v28, v23
    v_mul_f32 v30, v30, v23
    s_waitcnt lgkmcnt(0)
    v_mul_f32 v48, v24, v32
    v_mul_f32 v49, v24, v33
    v_mul_f32 v50, v24, v34
    v_mul_f32 v51, v24, v35
    v_fma_f32 v48, v26, v36, v48
    v_fma_f32 v49, v26, v37, v49
    v_fma_f32 v50, v26, v38, v50
    v_fma_f32 v51, v26, v39, v51
    v_fma_f32 v48, v28, v40, v48
    v_fma_f32 v49, v28, v41, v49
    v_fma_f32 v50, v28, v42, v50
    v_fma_f32 v51, v28, v43, v51
    v_fma_f32 v48, v30, v44, v48
    v_fma_f32 v49, v30, v45, v49
    v_fma_f32 v50, v30, v46, v50
    v_fma_f32 v51, v30, v47, v51
    v_lshlrev_b32 v19, 5, v18
    v_lshrrev_b32 v20, 4, v1
    v_lshl_add_u32 v19, v20, 7, v19
    v_and_b32 v20, 7, v1
    v_lshl_add_u32 v19, v20, 4, v19
    s_lshl_b32 s77, s72, 9
    s_add_u32 s77, s77, s87
    s_add_u32 s77, s77, s66
    s_cbranch_execz Ld_41
    buffer_store_dwordx4 v[48:51], v19, s[12:15], s77 offen
Ld_41:
    s_cmp_lg_u32 s62, 0
    s_cbranch_scc1 Lapk_40
    v_lshrrev_b32 v18, 3, v18
    s_lshl_b32 s77, s74, 3
    s_add_u32 s77, s77, 12288
    s_add_u32 s77, s77, s68
    s_add_u32 s77, s77, s93
    s_and_b32 exec_lo, s60, 0x101
    s_and_b32 exec_hi, s60, 0x0
    s_cbranch_execz Ld_42
    buffer_store_dword v22, v18, s[12:15], s77 offen
Ld_42:
    s_mov_b64 exec, s[60:61]
Lapk_40:
    s_cmp_lt_u32 s62, 2
    s_cbranch_scc1 Lgu_43
    s_cmp_eq_u32 s63, 1
    s_cbranch_scc1 Lgu_43
    s_cmp_ge_u32 s74, 28
    s_cbranch_scc1 Lgu_43
    s_sub_u32 s78, s72, 2
    s_mul_i32 s77, s78, 224
    s_mul_i32 s88, s78, 3584
    s_lshl_b32 s89, s97, 4
    v_add_u32 v56, 0, v1
    v_add_u32 v56, s77, v56
    v_and_b32 v58, 3, v56
    v_lshlrev_b32 v58, 3, v58
    v_bfe_u32 v57, v56, 2, 3
    v_or_b32 v58, v58, v57
    v_and_b32 v57, 0xffffffe0, v56
    v_or_b32 v57, v57, v58
    v_mul_u32_u24 v57, 3584, v57
    s_add_u32 m0, s88, 26624
    s_nop 0
    buffer_load_dwordx4 v57, s[28:31], s89 offen  lds
    s_add_u32 m0, s88, 33792
    s_nop 0
    buffer_load_dwordx4 v57, s[32:35], s89 offen  lds
    v_add_u32 v56, 64, v1
    v_add_u32 v56, s77, v56
    v_and_b32 v58, 3, v56
    v_lshlrev_b32 v58, 3, v58
    v_bfe_u32 v57, v56, 2, 3
    v_or_b32 v58, v58, v57
    v_and_b32 v57, 0xffffffe0, v56
    v_or_b32 v57, v57, v58
    v_mul_u32_u24 v57, 3584, v57
    s_add_u32 m0, s88, 27648
    s_nop 0
    buffer_load_dwordx4 v57, s[28:31], s89 offen  lds
    s_add_u32 m0, s88, 34816
    s_nop 0
    buffer_load_dwordx4 v57, s[32:35], s89 offen  lds
    v_add_u32 v56, 128, v1
    v_add_u32 v56, s77, v56
    v_and_b32 v58, 3, v56
    v_lshlrev_b32 v58, 3, v58
    v_bfe_u32 v57, v56, 2, 3
    v_or_b32 v58, v58, v57
    v_and_b32 v57, 0xffffffe0, v56
    v_or_b32 v57, v57, v58
    v_mul_u32_u24 v57, 3584, v57
    s_add_u32 m0, s88, 28672
    s_nop 0
    buffer_load_dwordx4 v57, s[28:31], s89 offen  lds
    s_add_u32 m0, s88, 35840
    s_nop 0
    buffer_load_dwordx4 v57, s[32:35], s89 offen  lds
    v_add_u32 v56, 192, v1
    v_add_u32 v56, s77, v56
    v_and_b32 v58, 3, v56
    v_lshlrev_b32 v58, 3, v58
    v_bfe_u32 v57, v56, 2, 3
    v_or_b32 v58, v58, v57
    v_and_b32 v57, 0xffffffe0, v56
    v_or_b32 v57, v57, v58
    v_mul_u32_u24 v57, 3584, v57
    s_and_b32 exec_lo, s60, 0xffffffff
    s_and_b32 exec_hi, s60, 0x0
    s_add_u32 m0, s88, 29696
    s_nop 0
    buffer_load_dwordx4 v57, s[28:31], s89 offen  lds
    s_add_u32 m0, s88, 36864
    s_nop 0
    buffer_load_dwordx4 v57, s[32:35], s89 offen  lds
    s_mov_b64 exec, s[60:61]
Lgu_43:
    s_cbranch_execz L_dryret
Lseg_44:
    s_lshl_b32 s77, s72, 11
    s_add_u32 s77, s77, s87
    s_add_u32 s77, s77, 18432
    s_add_u32 s77, s77, s67
    v_mov_b32 v88, -1
    v_mov_b32 v89, -1
    v_mov_b32 v90, -1
    v_mov_b32 v91, -1
    s_cbranch_execz Ld_45
    buffer_store_dwordx4 v[88:91], v8, s[12:15], s77 offen
    s_cmp_eq_u32 s72, 3
    s_cbranch_scc1 Lrp_46
    buffer_store_dwordx4 v[88:91], v8, s[12:15], s77 offen offset:1024
Lrp_46:
Ld_45:
    s_lshl_b32 s78, s72, 12
    v_add_u32 v57, s78, v8
    ds_read_b128 v[64:67], v57 offset:40960
    ds_read_b128 v[68:71], v57 offset:41984
    ds_read_b128 v[72:75], v57 offset:43008
    ds_read_b128 v[76:79], v57 offset:44032
    v_and_b32 v56, 15, v1
    v_lshlrev_b32 v58, 3, v56
    v_lshl_add_u32 v56, v56, 3, s73
    v_lshlrev_b32 v56, 15, v56
    v_lshrrev_b32 v57, 4, v1
    v_lshl_add_u32 v56, v57, 4, v56
    s_lshl_b32 s77, s74, 6
    s_add_u32 s77, s77, 524288
    s_add_u32 s77, s77, s66
    s_add_u32 s78, s77, 4194304
    s_lshr_b32 s88, s74, 4
    s_lshl_b32 s88, s88, 2
    s_add_u32 s88, s88, 12288
    s_add_u32 s88, s88, s68
    s_add_u32 s88, s88, s93
    s_mov_b64 s[94:95], s[60:61]
    s_cbranch_execz Lgc_48
    s_sleep 6
Lg_47:
    s_mov_b64 exec, s[94:95]
    buffer_load_dwordx4 v[40:43], v56, s[12:15], s77 offen sc1
    buffer_load_dwordx4 v[44:47], v56, s[12:15], s78 offen sc1
    buffer_load_dword v62, v58, s[12:15], s88 offen sc1
    buffer_load_dword v63, v58, s[12:15], s88 offen offset:128 sc1
    s_mov_b64 exec, s[60:61]
    s_waitcnt vmcnt(0) lgkmcnt(0)
Lgc_48:
    v_max3_u32 v59, v40, v41, v42
    v_max3_u32 v59, v59, v43, v44
    v_max3_u32 v59, v59, v45, v46
    v_max3_u32 v59, v59, v47, v62
    v_max_u32 v59, v59, v63
    v_cmp_eq_u32 vcc, -1, v59
    s_cbranch_vccz Lgo_49
    s_mov_b64 s[94:95], vcc
    s_sub_u32 s79, s79, 1
    s_cbranch_scc0 Lg_47
    s_branch L_end
Lgo_49:
    s_cbranch_execz L_dryret
Lseg_50:
    v_mov_b32 v26, v62
    v_mov_b32 v27, v63
    s_nop 0
    v_max_f32_dpp v26, v26, v26 quad_perm:[1,0,3,2] row_mask:0xf bank_mask:0xf
    v_max_f32_dpp v27, v27, v27 quad_perm:[1,0,3,2] row_mask:0xf bank_mask:0xf
    s_nop 0
    v_max_f32_dpp v26, v26, v26 quad_perm:[2,3,0,1] row_mask:0xf bank_mask:0xf
    v_max_f32_dpp v27, v27, v27 quad_perm:[2,3,0,1] row_mask:0xf bank_mask:0xf
    s_nop 0
    v_max_f32_dpp v26, v26, v26 row_half_mirror row_mask:0xf bank_mask:0xf
    v_max_f32_dpp v27, v27, v27 row_half_mirror row_mask:0xf bank_mask:0xf
    s_nop 0
    v_sub_f32 v24, v62, v26
    v_sub_f32 v25, v63, v27
    v_exp_f32 v24, v24
    v_exp_f32 v25, v25
    s_nop 0
    v_mov_b32 v26, v24
    v_mov_b32 v27, v25
    s_nop 0
    v_add_f32_dpp v26, v26, v26 quad_perm:[1,0,3,2] row_mask:0xf bank_mask:0xf
    v_add_f32_dpp v27, v27, v27 quad_perm:[1,0,3,2] row_mask:0xf bank_mask:0xf
    s_nop 0
    v_add_f32_dpp v26, v26, v26 quad_perm:[2,3,0,1] row_mask:0xf bank_mask:0xf
    v_add_f32_dpp v27, v27, v27 quad_perm:[2,3,0,1] row_mask:0xf bank_mask:0xf
    s_nop 0
    v_add_f32_dpp v26, v26, v26 row_half_mirror row_mask:0xf bank_mask:0xf
    v_add_f32_dpp v27, v27, v27 row_half_mirror row_mask:0xf bank_mask:0xf
    s_nop 0
    v_rcp_f32 v26, v26
    v_rcp_f32 v27, v27
    s_nop 0
    v_mul_f32 v24, v24, v26
    v_mul_f32 v25, v25, v27
    v_mul_f32 v16, v24, v40
    v_mul_f32 v17, v24, v41
    v_mul_f32 v18, v24, v42
    v_mul_f32 v19, v24, v43
    v_mul_f32 v20, v25, v44
    v_mul_f32 v21, v25, v45
    v_mul_f32 v22, v25, v46
    v_mul_f32 v23, v25, v47
    v_add_f32_dpp v16, v16, v16 quad_perm:[1,0,3,2] row_mask:0xf bank_mask:0xf
    v_add_f32_dpp v17, v17, v17 quad_perm:[1,0,3,2] row_mask:0xf bank_mask:0xf
    v_add_f32_dpp v18, v18, v18 quad_perm:[1,0,3,2] row_mask:0xf bank_mask:0xf
    v_add_f32_dpp v19, v19, v19 quad_perm:[1,0,3,2] row_mask:0xf bank_mask:0xf
    v_add_f32_dpp v20, v20, v20 quad_perm:[1,0,3,2] row_mask:0xf bank_mask:0xf
    v_add_f32_dpp v21, v21, v21 quad_perm:[1,0,3,2] row_mask:0xf bank_mask:0xf
    v_add_f32_dpp v22, v22, v22 quad_perm:[1,0,3,2] row_mask:0xf bank_mask:0xf
    v_add_f32_dpp v23, v23, v23 quad_perm:[1,0,3,2] row_mask:0xf bank_mask:0xf
    v_add_f32_dpp v16, v16, v16 quad_perm:[2,3,0,1] row_mask:0xf bank_mask:0xf
    v_add_f32_dpp v17, v17, v17 quad_perm:[2,3,0,1] row_mask:0xf bank_mask:0xf
    v_add_f32_dpp v18, v18, v18 quad_perm:[2,3,0,1] row_mask:0xf bank_mask:0xf
    v_add_f32_dpp v19, v19, v19 quad_perm:[2,3,0,1] row_mask:0xf bank_mask:0xf
    v_add_f32_dpp v20, v20, v20 quad_perm:[2,3,0,1] row_mask:0xf bank_mask:0xf
    v_add_f32_dpp v21, v21, v21 quad_perm:[2,3,0,1] row_mask:0xf bank_mask:0xf
    v_add_f32_dpp v22, v22, v22 quad_perm:[2,3,0,1] row_mask:0xf bank_mask:0xf
    v_add_f32_dpp v23, v23, v23 quad_perm:[2,3,0,1] row_mask:0xf bank_mask:0xf
    v_add_f32_dpp v16, v16, v16 row_half_mirror row_mask:0xf bank_mask:0xf
    v_add_f32_dpp v17, v17, v17 row_half_mirror row_mask:0xf bank_mask:0xf
    v_add_f32_dpp v18, v18, v18 row_half_mirror row_mask:0xf bank_mask:0xf
    v_add_f32_dpp v19, v19, v19 row_half_mirror row_mask:0xf bank_mask:0xf
    v_add_f32_dpp v20, v20, v20 row_half_mirror row_mask:0xf bank_mask:0xf
    v_add_f32_dpp v21, v21, v21 row_half_mirror row_mask:0xf bank_mask:0xf
    v_add_f32_dpp v22, v22, v22 row_half_mirror row_mask:0xf bank_mask:0xf
    v_add_f32_dpp v23, v23, v23 row_half_mirror row_mask:0xf bank_mask:0xf
    v_cvt_pk_bf16_f32 v16, v16, v16
    v_cvt_pk_bf16_f32 v17, v17, v17
    v_cvt_pk_bf16_f32 v18, v18, v18
    v_cvt_pk_bf16_f32 v19, v19, v19
    v_cvt_pk_bf16_f32 v20, v20, v20
    v_cvt_pk_bf16_f32 v21, v21, v21
    v_cvt_pk_bf16_f32 v22, v22, v22
    v_cvt_pk_bf16_f32 v23, v23, v23
    v_and_b32 v24, v16, v2
    v_and_b32 v25, v16, v3
    v_and_b32 v26, v16, v4
    v_and_b32 v27, v16, v5
    s_nop 1
    v_mfma_f32_16x16x32_bf16 v[48:51], v[64:67], v[24:27], 0
    v_and_b32 v28, v20, v2
    v_and_b32 v29, v20, v3
    v_and_b32 v30, v20, v4
    v_and_b32 v31, v20, v5
    s_nop 1
    v_mfma_f32_16x16x32_bf16 v[52:55], v[64:67], v[28:31], 0
    v_and_b32 v32, v17, v2
    v_and_b32 v33, v17, v3
    v_and_b32 v34, v17, v4
    v_and_b32 v35, v17, v5
    s_nop 1
    v_mfma_f32_16x16x32_bf16 v[48:51], v[68:71], v[32:35], v[48:51]
    v_and_b32 v36, v21, v2
    v_and_b32 v37, v21, v3
    v_and_b32 v38, v21, v4
    v_and_b32 v39, v21, v5
    s_nop 1
    v_mfma_f32_16x16x32_bf16 v[52:55], v[68:71], v[36:39], v[52:55]
    v_and_b32 v24, v18, v2
    v_and_b32 v25, v18, v3
    v_and_b32 v26, v18, v4
    v_and_b32 v27, v18, v5
    s_nop 1
    v_mfma_f32_16x16x32_bf16 v[48:51], v[72:75], v[24:27], v[48:51]
    v_and_b32 v28, v22, v2
    v_and_b32 v29, v22, v3
    v_and_b32 v30, v22, v4
    v_and_b32 v31, v22, v5
    s_nop 1
    v_mfma_f32_16x16x32_bf16 v[52:55], v[72:75], v[28:31], v[52:55]
    v_and_b32 v32, v19, v2
    v_and_b32 v33, v19, v3
    v_and_b32 v34, v19, v4
    v_and_b32 v35, v19, v5
    s_nop 1
    v_mfma_f32_16x16x32_bf16 v[48:51], v[76:79], v[32:35], v[48:51]
    v_and_b32 v36, v23, v2
    v_and_b32 v37, v23, v3
    v_and_b32 v38, v23, v4
    v_and_b32 v39, v23, v5
    s_nop 1
    v_mfma_f32_16x16x32_bf16 v[52:55], v[76:79], v[36:39], v[52:55]
    s_lshl_b32 s77, s72, 11
    s_add_u32 s77, s77, s87
    s_add_u32 s77, s77, 4096
    s_add_u32 s77, s77, s67
    v_lshlrev_b32 v56, 5, v1
    s_nop 3
    s_and_b64 exec, s[84:85], s[60:61]
    s_cbranch_execz Ld_51
    buffer_store_dwordx4 v[48:51], v56, s[12:15], s77 offen
Ld_51:
    s_cbranch_execz Ld_52
    buffer_store_dwordx4 v[52:55], v56, s[12:15], s77 offen offset:16
Ld_52:
    s_mov_b64 exec, s[60:61]
    s_cbranch_execz L_dryret
Lseg_53:
    v_lshrrev_b32 v57, 4, v1
    v_and_b32 v58, 15, v1
    v_lshlrev_b32 v56, 18, v57
    v_lshl_add_u32 v56, v58, 4, v56
    s_lshl_b32 s77, s72, 20
    s_lshl_b32 s78, s73, 15
    s_add_u32 s77, s77, s78
    s_mul_i32 s78, s74, 224
    s_add_u32 s77, s77, s78
    s_add_u32 s77, s77, 528384
    s_add_u32 s77, s77, s67
    s_add_u32 s78, s77, 4194304
    v_mul_u32_u24 v57, 288, v57
    v_lshl_add_u32 v58, v58, 4, v57
    s_mul_i32 s89, s72, 1152
    v_add_u32 v58, s89, v58
    v_and_b32 v60, 3, v1
    v_mul_u32_u24 v60, 288, v60
    v_and_b32 v61, 60, v1
    s_lshl_b32 s89, s72, 6
    v_add_u32 v61, s89, v61
    v_add_u32 v60, v60, v61
    v_mov_b32 v80, 0
    v_mov_b32 v81, 0
    v_mov_b32 v82, 0
    v_mov_b32 v83, 0
    v_mov_b32 v84, 0
    v_mov_b32 v85, 0
    v_mov_b32 v86, 0
    v_mov_b32 v87, 0
    s_mov_b64 s[94:95], s[60:61]
    s_cbranch_execz Lgc_55
    s_sleep 6
Lg_54:
    s_and_b64 exec, s[94:95], s[98:99]
    buffer_load_dwordx4 v[80:83], v56, s[12:15], s77 offen sc1
    buffer_load_dwordx4 v[84:87], v56, s[12:15], s78 offen sc1
    s_mov_b64 exec, s[60:61]
    s_waitcnt vmcnt(0) lgkmcnt(0)
Lgc_55:
    v_max3_u32 v59, v80, v81, v82
    v_max3_u32 v59, v59, v83, v84
    v_max3_u32 v59, v59, v85, v86
    v_max_u32 v59, v59, v87
    v_cmp_eq_u32 vcc, -1, v59
    s_cbranch_vccz Lgo_56
    s_mov_b64 s[94:95], vcc
    s_sub_u32 s79, s79, 1
    s_cbranch_scc0 Lg_54
    s_branch L_end
Lgo_56:
    v_add_f32 v16, v80, v84
    v_add_f32 v17, v81, v85
    v_add_f32 v18, v82, v86
    v_add_f32 v19, v83, v87
    ds_write_b128 v58, v[16:19] offset:0
    s_waitcnt lgkmcnt(0)
    s_cbranch_execz Ld_57
    s_barrier
Ld_57:
    ds_read_b32 v16, v60 offset:0
    ds_read_b32 v17, v60 offset:1152
    ds_read_b32 v18, v60 offset:2304
    ds_read_b32 v19, v60 offset:3456
    s_lshl_b32 s77, s96, 10
    s_add_u32 s77, s77, 262144
    s_add_u32 s77, s77, s69
    s_waitcnt lgkmcnt(0)
    v_add_f32 v16, v16, v17
    v_add_f32 v18, v18, v19
    v_add_f32 v16, v16, v18
    s_nop 1
    v_add_f32_dpp v16, v16, v16 quad_perm:[1,0,3,2] row_mask:0xf bank_mask:0xf
    s_nop 1
    v_add_f32_dpp v16, v16, v16 quad_perm:[2,3,0,1] row_mask:0xf bank_mask:0xf
    s_and_b32 exec_lo, s60, 0x11111111
    s_and_b32 exec_hi, s85, exec_lo
    s_cbranch_execz Ld_58
    buffer_store_dword v16, v61, s[12:15], s77 offen sc1
Ld_58:
    s_mov_b64 exec, s[60:61]
    s_cbranch_execz L_dryret
Lseg_59:
    s_cmp_ge_u32 s62, 2
    s_cbranch_scc1 Lrsk_60
    v_lshrrev_b32 v60, 3, v1
    s_mul_i32 s89, s72, 7
    v_add_u32 v60, s89, v60
    v_lshrrev_b32 v61, 1, v60
    s_mul_i32 s89, s74, 7
    v_add_u32 v61, s89, v61
    v_and_b32 v62, 1, v60
    v_bfe_u32 v63, v61, 3, 1
    v_lshl_add_u32 v62, v62, 1, v63
    v_mul_u32_u24 v62, 896, v62
    v_lshrrev_b32 v63, 4, v61
    v_lshl_add_u32 v62, v63, 6, v62
    v_and_b32 v63, 7, v61
    v_lshl_add_u32 v57, v63, 3, v62
    v_and_b32 v56, 7, v1
    v_lshlrev_b32 v56, 10, v56
    v_lshl_add_u32 v56, v60, 4, v56
    s_lshl_b32 s77, s74, 13
    s_add_u32 s77, s77, 262144
    s_add_u32 s77, s77, s69
    v_mov_b32 v48, 0
    v_mov_b32 v49, 0
    v_mov_b32 v50, 0
    v_mov_b32 v51, 0
    v_lshlrev_b32 v20, 16, v9
    v_and_b32 v21, 0xffff0000, v9
    v_lshlrev_b32 v22, 16, v0
    v_and_b32 v23, 0xffff0000, v0
    s_mov_b64 s[94:95], s[60:61]
    s_cbranch_execz Lgc_62
    s_sleep 10
Lg_61:
    s_and_b64 exec, s[94:95], s[100:101]
    buffer_load_dwordx4 v[48:51], v56, s[12:15], s77 offen sc1
    s_mov_b64 exec, s[60:61]
    s_waitcnt vmcnt(0) lgkmcnt(0)
Lgc_62:
    v_max3_u32 v59, v48, v49, v50
    v_max_u32 v59, v59, v51
    v_cmp_eq_u32 vcc, -1, v59
    s_cbranch_vccz Lgo_63
    s_mov_b64 s[94:95], vcc
    s_sub_u32 s79, s79, 1
    s_cbranch_scc0 Lg_61
    s_branch L_end
Lgo_63:
    v_add_f32_dpp v16, v48, v48 quad_perm:[1,0,3,2] row_mask:0xf bank_mask:0xf
    v_add_f32_dpp v17, v49, v49 quad_perm:[1,0,3,2] row_mask:0xf bank_mask:0xf
    v_add_f32_dpp v18, v50, v50 quad_perm:[1,0,3,2] row_mask:0xf bank_mask:0xf
    v_add_f32_dpp v19, v51, v51 quad_perm:[1,0,3,2] row_mask:0xf bank_mask:0xf
    v_add_f32_dpp v16, v16, v16 quad_perm:[2,3,0,1] row_mask:0xf bank_mask:0xf
    v_add_f32_dpp v17, v17, v17 quad_perm:[2,3,0,1] row_mask:0xf bank_mask:0xf
    v_add_f32_dpp v18, v18, v18 quad_perm:[2,3,0,1] row_mask:0xf bank_mask:0xf
    v_add_f32_dpp v19, v19, v19 quad_perm:[2,3,0,1] row_mask:0xf bank_mask:0xf
    v_add_f32_dpp v16, v16, v16 row_half_mirror row_mask:0xf bank_mask:0xf
    v_add_f32_dpp v17, v17, v17 row_half_mirror row_mask:0xf bank_mask:0xf
    v_add_f32_dpp v18, v18, v18 row_half_mirror row_mask:0xf bank_mask:0xf
    v_add_f32_dpp v19, v19, v19 row_half_mirror row_mask:0xf bank_mask:0xf
    v_cvt_pk_bf16_f32 v16, v16, v16
    v_and_b32 v16, 0xffff0000, v16
    v_cvt_pk_bf16_f32 v17, v17, v17
    v_and_b32 v17, 0xffff0000, v17
    v_cvt_pk_bf16_f32 v18, v18, v18
    v_and_b32 v18, 0xffff0000, v18
    v_cvt_pk_bf16_f32 v19, v19, v19
    v_and_b32 v19, 0xffff0000, v19
    v_add_f32 v16, v16, v20
    v_add_f32 v17, v17, v21
    v_add_f32 v18, v18, v22
    v_add_f32 v19, v19, v23
    v_cvt_pk_bf16_f32 v24, v16, v17
    v_cvt_pk_bf16_f32 v25, v18, v19
    s_and_b32 exec_lo, s60, 0x1010101
    s_and_b32 exec_hi, s60, 0x10101
    s_add_u32 s77, s93, 0
    s_add_u32 s77, s77, s70
    s_cbranch_execz Ld_64
    buffer_store_dwordx2 v[24:25], v57, s[12:15], s77 offen
Ld_64:
    s_mov_b64 exec, s[60:61]
    v_mov_b32 v9, v24
    v_mov_b32 v0, v25
Lrsk_60:
    s_cbranch_execz L_dryret
Lseg_65:
    s_cmp_ge_u32 s74, 28
    s_cbranch_scc1 Lnoffn_66
    s_cmp_lt_u32 s62, 2
    s_cbranch_scc1 Lgu_67
    s_cmp_eq_u32 s63, 1
    s_cbranch_scc1 Lgu_67
    s_sub_u32 s78, s72, 2
    s_lshl_b32 s77, s78, 12
    s_add_u32 s77, s77, s87
    s_add_u32 s77, s77, 18432
    buffer_load_dwordx4 v[84:87], v8, s[12:15], s77 offen offset:0 nt
    buffer_load_dwordx4 v[84:87], v8, s[12:15], s77 offen offset:1024 nt
    buffer_load_dwordx4 v[84:87], v8, s[12:15], s77 offen offset:2048 nt
    buffer_load_dwordx4 v[84:87], v8, s[12:15], s77 offen offset:3072 nt
Lgu_67:
    ds_read_b64_tr_b16 v[32:33], v12 offset:0
    ds_read_b64_tr_b16 v[34:35], v12 offset:64
    ds_read_b64_tr_b16 v[36:37], v12 offset:512
    ds_read_b64_tr_b16 v[38:39], v12 offset:576
    ds_read_b64_tr_b16 v[40:41], v12 offset:1024
    ds_read_b64_tr_b16 v[42:43], v12 offset:1088
    ds_read_b64_tr_b16 v[44:45], v14 offset:1536
    ds_read_b64_tr_b16 v[46:47], v14 offset:1600
    v_mov_b32 v16, 0x3f803f80
    v_mov_b32 v17, 0x3f803f80
    v_mov_b32 v18, 0x3f803f80
    v_mov_b32 v19, 0x3f803f80
    v_mov_b32 v20, 0x3f803f80
    v_mov_b32 v21, 0x3f803f80
    v_mov_b32 v22, 0x3f803f80
    v_mov_b32 v23, 0x3f803f80
    v_mov_b32 v24, 0x3f803f80
    v_mov_b32 v25, 0x3f803f80
    v_mov_b32 v26, 0x3f803f80
    v_mov_b32 v27, 0x3f803f80
    v_cmp_gt_u32 vcc, 32, v1
    v_mov_b32 v56, 0x3f803f80
    s_nop 0
    v_cndmask_b32 v28, 0, v56, vcc
    v_cndmask_b32 v29, 0, v56, vcc
    v_cndmask_b32 v30, 0, v56, vcc
    v_cndmask_b32 v31, 0, v56, vcc
    s_lshl_b32 s78, s72, 11
    v_add_u32 v57, s78, v8
    ds_read_b128 v[64:67], v57 offset:57344
    ds_read_b128 v[68:71], v57 offset:58368
    v_and_b32 v72, 1, v1
    v_bfe_u32 v73, v1, 3, 1
    v_lshl_add_u32 v72, v72, 1, v73
    v_bfe_u32 v73, v1, 1, 1
    v_lshrrev_b32 v74, 4, v1
    v_lshl_add_u32 v73, v73, 2, v74
    v_lshlrev_b32 v73, 4, v73
    v_lshl_add_u32 v74, v72, 8, v73
    v_mul_u32_u24 v75, 272, v72
    v_lshlrev_b32 v76, 4, v72
    s_add_u32 s77, s93, s70
    s_mov_b64 s[94:95], s[60:61]
    s_cbranch_execz Lgc_69
Lg_68:
    s_and_b64 exec, s[94:95], s[80:81]
    buffer_load_dwordx4 v[16:19], v10, s[12:15], s77 offen offset:0 sc1
    buffer_load_dwordx4 v[20:23], v10, s[12:15], s77 offen offset:64 sc1
    buffer_load_dwordx4 v[24:27], v10, s[12:15], s77 offen offset:128 sc1
    s_and_b64 exec, s[94:95], s[82:83]
    buffer_load_dwordx4 v[28:31], v10, s[12:15], s77 offen offset:192 sc1
    s_mov_b64 exec, s[60:61]
    s_waitcnt vmcnt(0) lgkmcnt(0)
Lgc_69:
    v_max3_u32 v56, v16, v17, v18
    v_max3_u32 v56, v56, v19, v20
    v_max3_u32 v56, v56, v21, v22
    v_max3_u32 v56, v56, v23, v24
    v_max3_u32 v56, v56, v25, v26
    v_max3_u32 v56, v56, v27, v28
    v_max3_u32 v56, v56, v29, v30
    v_max_u32 v56, v56, v31
    v_cmp_eq_u32 vcc, -1, v56
    s_cbranch_vccz Lgo_70
    s_mov_b64 s[94:95], vcc
    s_sub_u32 s79, s79, 1
    s_cbranch_scc0 Lg_68
    s_branch L_end
Lgo_70:
    v_mfma_f32_16x16x32_bf16 v[48:51], v[16:19], v[32:35], 0
    v_mfma_f32_16x16x32_bf16 v[52:55], v[16:19], v[16:19], 0
    v_mfma_f32_16x16x32_bf16 v[48:51], v[20:23], v[36:39], v[48:51]
    v_mfma_f32_16x16x32_bf16 v[52:55], v[20:23], v[20:23], v[52:55]
    v_mfma_f32_16x16x32_bf16 v[48:51], v[24:27], v[40:43], v[48:51]
    v_mfma_f32_16x16x32_bf16 v[52:55], v[24:27], v[24:27], v[52:55]
    v_mfma_f32_16x16x32_bf16 v[48:51], v[28:31], v[44:47], v[48:51]
    v_mfma_f32_16x16x32_bf16 v[52:55], v[28:31], v[28:31], v[52:55]
    s_nop 7
    ds_write_b32 v15, v48 offset:0
    ds_write_b32 v15, v49 offset:256
    ds_write_b32 v15, v50 offset:512
    ds_write_b32 v15, v51 offset:768
    ds_write_b32 v15, v52 offset:4096
    ds_write_b32 v15, v53 offset:4352
    ds_write_b32 v15, v54 offset:4608
    ds_write_b32 v15, v55 offset:4864
    s_waitcnt lgkmcnt(0)
    s_cbranch_execz Ld_71
    s_barrier
Ld_71:
    s_cbranch_execz L_dryret
Lseg_72:
    ds_read_b128 v[32:35], v74 offset:0
    ds_read_b128 v[36:39], v74 offset:128
    ds_read_b128 v[40:43], v73 offset:1024
    ds_read_b128 v[44:47], v73 offset:1152
    ds_read_b128 v[80:83], v75 offset:4096
    ds_read_b128 v[84:87], v76 offset:5120
    s_waitcnt lgkmcnt(0)
    v_add_f32 v84, v84, v85
    v_add_f32 v86, v86, v87
    v_add_f32 v58, v84, v86
    v_add_f32 v80, v80, v81
    v_add_f32 v82, v82, v83
    v_add_f32 v59, v80, v82
    v_mul_f32 v58, 0x3b124925, v58
    v_mul_f32 v59, 0x3b124925, v59
    v_fma_f32 v59, -v58, v58, v59
    v_max_f32 v59, 0, v59
    v_add_f32 v59, 0x3727c5ac, v59
    v_rsq_f32 v59, v59
    v_add_f32 v32, v32, v33
    v_add_f32 v34, v34, v35
    v_add_f32 v60, v32, v34
    v_add_f32 v36, v36, v37
    v_add_f32 v38, v38, v39
    v_add_f32 v61, v36, v38
    v_add_f32 v40, v40, v41
    v_add_f32 v42, v42, v43
    v_add_f32 v62, v40, v42
    v_add_f32 v44, v44, v45
    v_add_f32 v46, v46, v47
    v_add_f32 v63, v44, v46
    v_fma_f32 v60, -v58, v62, v60
    v_fma_f32 v61, -v58, v63, v61
    v_mul_f32 v60, v59, v60
    v_mul_f32 v61, v59, v61
    v_cvt_pk_bf16_f32 v60, v60, v60
    v_and_b32 v60, 0xffff0000, v60
    v_cvt_pk_bf16_f32 v61, v61, v61
    v_and_b32 v61, 0xffff0000, v61
    v_mul_f32 v62, v60, v60
    v_mul_f32 v62, 0x3d372713, v62
    v_fma_f32 v62, v62, v60, v60
    v_mul_f32 v62, 0xc0135761, v62
    v_exp_f32 v62, v62
    s_nop 0
    v_add_f32 v62, 1.0, v62
    v_rcp_f32 v62, v62
    s_nop 0
    v_mul_f32 v62, v60, v62
    v_cvt_pk_bf16_f32 v62, v62, v62
    v_and_b32 v62, 0xffff0000, v62
    v_mul_f32 v62, v62, v61
    v_cvt_pk_bf16_f32 v62, v62, v62
    s_nop 1
    v_and_b32_dpp v32, v62, v2 quad_perm:[0,0,0,0] row_mask:0xf bank_mask:0xf
    v_and_b32_dpp v33, v62, v3 quad_perm:[0,0,0,0] row_mask:0xf bank_mask:0xf
    v_and_b32_dpp v34, v62, v4 quad_perm:[0,0,0,0] row_mask:0xf bank_mask:0xf
    v_and_b32_dpp v35, v62, v5 quad_perm:[0,0,0,0] row_mask:0xf bank_mask:0xf
    v_and_b32_dpp v36, v62, v2 quad_perm:[1,1,1,1] row_mask:0xf bank_mask:0xf
    v_and_b32_dpp v37, v62, v3 quad_perm:[1,1,1,1] row_mask:0xf bank_mask:0xf
    v_and_b32_dpp v38, v62, v4 quad_perm:[1,1,1,1] row_mask:0xf bank_mask:0xf
    v_and_b32_dpp v39, v62, v5 quad_perm:[1,1,1,1] row_mask:0xf bank_mask:0xf
    v_and_b32_dpp v40, v62, v2 quad_perm:[2,2,2,2] row_mask:0xf bank_mask:0xf
    v_and_b32_dpp v41, v62, v3 quad_perm:[2,2,2,2] row_mask:0xf bank_mask:0xf
    v_and_b32_dpp v42, v62, v4 quad_perm:[2,2,2,2] row_mask:0xf bank_mask:0xf
    v_and_b32_dpp v43, v62, v5 quad_perm:[2,2,2,2] row_mask:0xf bank_mask:0xf
    v_and_b32_dpp v44, v62, v2 quad_perm:[3,3,3,3] row_mask:0xf bank_mask:0xf
    v_and_b32_dpp v45, v62, v3 quad_perm:[3,3,3,3] row_mask:0xf bank_mask:0xf
    v_and_b32_dpp v46, v62, v4 quad_perm:[3,3,3,3] row_mask:0xf bank_mask:0xf
    v_and_b32_dpp v47, v62, v5 quad_perm:[3,3,3,3] row_mask:0xf bank_mask:0xf
    s_nop 1
    v_mfma_f32_16x16x32_bf16 v[48:51], v[64:67], v[32:35], 0
    v_mfma_f32_16x16x32_bf16 v[52:55], v[64:67], v[36:39], 0
    v_mfma_f32_16x16x32_bf16 v[48:51], v[68:71], v[40:43], v[48:51]
    v_mfma_f32_16x16x32_bf16 v[52:55], v[68:71], v[44:47], v[52:55]
    s_lshl_b32 s77, s72, 11
    s_add_u32 s77, s77, s87
    s_add_u32 s77, s77, 18432
    s_add_u32 s77, s77, s67
    v_lshlrev_b32 v56, 5, v1
    s_nop 3
    s_and_b64 exec, s[84:85], s[60:61]
    s_cbranch_execz Ld_73
    buffer_store_dwordx4 v[48:51], v56, s[12:15], s77 offen
Ld_73:
    s_cbranch_execz Ld_74
    buffer_store_dwordx4 v[52:55], v56, s[12:15], s77 offen offset:16
Ld_74:
    s_mov_b64 exec, s[60:61]
Lnoffn_66:
    s_cbranch_execz L_dryret
Lseg_75:
    v_lshrrev_b32 v57, 4, v1
    v_and_b32 v58, 15, v1
    v_lshlrev_b32 v56, 18, v57
    v_lshl_add_u32 v56, v58, 4, v56
    s_lshl_b32 s77, s72, 20
    s_lshl_b32 s78, s73, 15
    s_add_u32 s77, s77, s78
    s_mul_i32 s78, s74, 224
    s_add_u32 s77, s77, s78
    s_add_u32 s77, s77, 542720
    s_add_u32 s77, s77, s67
    s_add_u32 s78, s77, 4194304
    s_cmp_eq_u32 s72, 3
    s_cselect_b32 s78, s77, s78
    s_cselect_b32 s88, 0, 1.0
    v_mul_u32_u24 v57, 288, v57
    v_lshl_add_u32 v58, v58, 4, v57
    s_mul_i32 s89, s72, 1152
    v_add_u32 v58, s89, v58
    v_and_b32 v60, 3, v1
    v_mul_u32_u24 v60, 288, v60
    v_and_b32 v61, 60, v1
    s_lshl_b32 s89, s72, 6
    v_add_u32 v61, s89, v61
    v_add_u32 v60, v60, v61
    v_mov_b32 v80, 0
    v_mov_b32 v81, 0
    v_mov_b32 v82, 0
    v_mov_b32 v83, 0
    v_mov_b32 v84, 0
    v_mov_b32 v85, 0
    v_mov_b32 v86, 0
    v_mov_b32 v87, 0
    s_mov_b64 s[94:95], s[60:61]
    s_cbranch_execz Lgc_77
    s_sleep 6
Lg_76:
    s_and_b64 exec, s[94:95], s[98:99]
    buffer_load_dwordx4 v[80:83], v56, s[12:15], s77 offen sc1
    buffer_load_dwordx4 v[84:87], v56, s[12:15], s78 offen sc1
    s_mov_b64 exec, s[60:61]
    s_waitcnt vmcnt(0) lgkmcnt(0)
Lgc_77:
    v_max3_u32 v59, v80, v81, v82
    v_max3_u32 v59, v59, v83, v84
    v_max3_u32 v59, v59, v85, v86
    v_max_u32 v59, v59, v87
    v_cmp_eq_u32 vcc, -1, v59
    s_cbranch_vccz Lgo_78
    s_mov_b64 s[94:95], vcc
    s_sub_u32 s79, s79, 1
    s_cbranch_scc0 Lg_76
    s_branch L_end
Lgo_78:
    v_fma_f32 v16, v84, s88, v80
    v_fma_f32 v17, v85, s88, v81
    v_fma_f32 v18, v86, s88, v82
    v_fma_f32 v19, v87, s88, v83
    ds_write_b128 v58, v[16:19] offset:0
    s_waitcnt lgkmcnt(0)
    s_cbranch_execz Ld_79
    s_barrier
Ld_79:
    ds_read_b32 v16, v60 offset:0
    ds_read_b32 v17, v60 offset:1152
    ds_read_b32 v18, v60 offset:2304
    ds_read_b32 v19, v60 offset:3456
    s_lshl_b32 s77, s96, 10
    s_add_u32 s77, s77, 262400
    s_add_u32 s77, s77, s69
    s_waitcnt lgkmcnt(0)
    v_add_f32 v16, v16, v17
    v_add_f32 v18, v18, v19
    v_add_f32 v16, v16, v18
    s_nop 1
    v_add_f32_dpp v16, v16, v16 quad_perm:[1,0,3,2] row_mask:0xf bank_mask:0xf
    s_nop 1
    v_add_f32_dpp v16, v16, v16 quad_perm:[2,3,0,1] row_mask:0xf bank_mask:0xf
    s_and_b32 exec_lo, s60, 0x11111111
    s_and_b32 exec_hi, s85, exec_lo
    s_cbranch_execz Ld_80
    buffer_store_dword v16, v61, s[12:15], s77 offen sc1
Ld_80:
    s_mov_b64 exec, s[60:61]
    s_cbranch_execz L_dryret
    s_cmp_eq_u32 s63, 1
    s_cbranch_scc1 L_final
    s_cbranch_execz L_dryret
Lseg_81:
    s_cmp_ge_u32 s62, 2
    s_cbranch_scc1 Lrsk_82
    v_lshrrev_b32 v60, 3, v1
    s_mul_i32 s89, s72, 7
    v_add_u32 v60, s89, v60
    v_lshrrev_b32 v61, 1, v60
    s_mul_i32 s89, s74, 7
    v_add_u32 v61, s89, v61
    v_and_b32 v62, 1, v60
    v_bfe_u32 v63, v61, 3, 1
    v_lshl_add_u32 v62, v62, 1, v63
    v_mul_u32_u24 v62, 896, v62
    v_lshrrev_b32 v63, 4, v61
    v_lshl_add_u32 v62, v63, 6, v62
    v_and_b32 v63, 7, v61
    v_lshl_add_u32 v57, v63, 3, v62
    v_and_b32 v56, 7, v1
    v_lshlrev_b32 v56, 10, v56
    v_lshl_add_u32 v56, v60, 4, v56
    s_lshl_b32 s77, s74, 13
    s_add_u32 s77, s77, 262400
    s_add_u32 s77, s77, s69
    v_mov_b32 v48, 0
    v_mov_b32 v49, 0
    v_mov_b32 v50, 0
    v_mov_b32 v51, 0
    v_lshlrev_b32 v20, 16, v9
    v_and_b32 v21, 0xffff0000, v9
    v_lshlrev_b32 v22, 16, v0
    v_and_b32 v23, 0xffff0000, v0
    s_mov_b64 s[94:95], s[60:61]
    s_cbranch_execz Lgc_84
    s_sleep 9
Lg_83:
    s_and_b64 exec, s[94:95], s[100:101]
    buffer_load_dwordx4 v[48:51], v56, s[12:15], s77 offen sc1
    s_mov_b64 exec, s[60:61]
    s_waitcnt vmcnt(0) lgkmcnt(0)
Lgc_84:
    v_max3_u32 v59, v48, v49, v50
    v_max_u32 v59, v59, v51
    v_cmp_eq_u32 vcc, -1, v59
    s_cbranch_vccz Lgo_85
    s_mov_b64 s[94:95], vcc
    s_sub_u32 s79, s79, 1
    s_cbranch_scc0 Lg_83
    s_branch L_end
Lgo_85:
    v_add_f32_dpp v16, v48, v48 quad_perm:[1,0,3,2] row_mask:0xf bank_mask:0xf
    v_add_f32_dpp v17, v49, v49 quad_perm:[1,0,3,2] row_mask:0xf bank_mask:0xf
    v_add_f32_dpp v18, v50, v50 quad_perm:[1,0,3,2] row_mask:0xf bank_mask:0xf
    v_add_f32_dpp v19, v51, v51 quad_perm:[1,0,3,2] row_mask:0xf bank_mask:0xf
    v_add_f32_dpp v16, v16, v16 quad_perm:[2,3,0,1] row_mask:0xf bank_mask:0xf
    v_add_f32_dpp v17, v17, v17 quad_perm:[2,3,0,1] row_mask:0xf bank_mask:0xf
    v_add_f32_dpp v18, v18, v18 quad_perm:[2,3,0,1] row_mask:0xf bank_mask:0xf
    v_add_f32_dpp v19, v19, v19 quad_perm:[2,3,0,1] row_mask:0xf bank_mask:0xf
    v_add_f32_dpp v16, v16, v16 row_half_mirror row_mask:0xf bank_mask:0xf
    v_add_f32_dpp v17, v17, v17 row_half_mirror row_mask:0xf bank_mask:0xf
    v_add_f32_dpp v18, v18, v18 row_half_mirror row_mask:0xf bank_mask:0xf
    v_add_f32_dpp v19, v19, v19 row_half_mirror row_mask:0xf bank_mask:0xf
    v_cvt_pk_bf16_f32 v16, v16, v16
    v_and_b32 v16, 0xffff0000, v16
    v_cvt_pk_bf16_f32 v17, v17, v17
    v_and_b32 v17, 0xffff0000, v17
    v_cvt_pk_bf16_f32 v18, v18, v18
    v_and_b32 v18, 0xffff0000, v18
    v_cvt_pk_bf16_f32 v19, v19, v19
    v_and_b32 v19, 0xffff0000, v19
    v_add_f32 v16, v16, v20
    v_add_f32 v17, v17, v21
    v_add_f32 v18, v18, v22
    v_add_f32 v19, v19, v23
    v_cvt_pk_bf16_f32 v24, v16, v17
    v_cvt_pk_bf16_f32 v25, v18, v19
    s_and_b32 exec_lo, s60, 0x1010101
    s_and_b32 exec_hi, s60, 0x10101
    s_add_u32 s77, s93, 4096
    s_cbranch_execz Ld_86
    buffer_store_dwordx2 v[24:25], v57, s[12:15], s77 offen
Ld_86:
    s_mov_b64 exec, s[60:61]
    v_mov_b32 v9, v24
    v_mov_b32 v0, v25
Lrsk_82:
    s_cbranch_execz L_dryret
Lseg_87:
    s_lshl_b32 s77, s72, 11
    s_add_u32 s77, s77, s87
    s_add_u32 s77, s77, 4096
    v_mov_b32 v88, -1
    v_mov_b32 v89, -1
    v_mov_b32 v90, -1
    v_mov_b32 v91, -1
    s_cbranch_execz Ld_88
    buffer_store_dwordx4 v[88:91], v8, s[12:15], s77 offen
    s_cmp_eq_u32 s72, 3
    s_cbranch_scc1 Lrp_89
    buffer_store_dwordx4 v[88:91], v8, s[12:15], s77 offen offset:1024
Lrp_89:
Ld_88:
    s_cmp_lg_u32 s62, 0
    s_cbranch_scc1 Lro_90
    s_cbranch_execz Ld_91
    buffer_store_dwordx4 v[88:91], v8, s[12:15], s87 offen offset:0
    buffer_store_dwordx4 v[88:91], v8, s[12:15], s87 offen offset:1024
Ld_91:
Lro_90:
    ds_read_b64_tr_b16 v[32:33], v11 offset:0
    ds_read_b64_tr_b16 v[34:35], v11 offset:128
    ds_read_b64_tr_b16 v[36:37], v11 offset:1024
    ds_read_b64_tr_b16 v[38:39], v11 offset:1152
    ds_read_b64_tr_b16 v[40:41], v11 offset:2048
    ds_read_b64_tr_b16 v[42:43], v11 offset:2176
    ds_read_b64_tr_b16 v[44:45], v13 offset:3072
    ds_read_b64_tr_b16 v[46:47], v13 offset:3200
    v_mov_b32 v16, 0x3f803f80
    v_mov_b32 v17, 0x3f803f80
    v_mov_b32 v18, 0x3f803f80
    v_mov_b32 v19, 0x3f803f80
    v_mov_b32 v20, 0x3f803f80
    v_mov_b32 v21, 0x3f803f80
    v_mov_b32 v22, 0x3f803f80
    v_mov_b32 v23, 0x3f803f80
    v_mov_b32 v24, 0x3f803f80
    v_mov_b32 v25, 0x3f803f80
    v_mov_b32 v26, 0x3f803f80
    v_mov_b32 v27, 0x3f803f80
    v_cmp_gt_u32 vcc, 32, v1
    v_mov_b32 v56, 0x3f803f80
    s_nop 0
    v_cndmask_b32 v28, 0, v56, vcc
    v_cndmask_b32 v29, 0, v56, vcc
    v_cndmask_b32 v30, 0, v56, vcc
    v_cndmask_b32 v31, 0, v56, vcc
    v_bfe_u32 v56, v1, 3, 1
    v_lshlrev_b32 v56, 9, v56
    v_lshrrev_b32 v57, 4, v1
    v_lshl_add_u32 v93, v57, 4, v56
    v_and_b32 v56, 1, v1
    v_lshl_add_u32 v93, v56, 6, v93
    s_lshl_b32 s88, s75, 10
    s_add_u32 s88, s88, s93
    s_add_u32 s88, s88, 20480
    s_mov_b32 s92, s88
    s_add_u32 s77, s93, 4096
    s_mov_b64 s[94:95], s[60:61]
    s_cbranch_execz Lgc_93
Lg_92:
    s_and_b64 exec, s[94:95], s[80:81]
    buffer_load_dwordx4 v[16:19], v10, s[12:15], s77 offen offset:0 sc1
    buffer_load_dwordx4 v[20:23], v10, s[12:15], s77 offen offset:64 sc1
    buffer_load_dwordx4 v[24:27], v10, s[12:15], s77 offen offset:128 sc1
    s_and_b64 exec, s[94:95], s[82:83]
    buffer_load_dwordx4 v[28:31], v10, s[12:15], s77 offen offset:192 sc1
    s_mov_b64 exec, s[60:61]
    s_waitcnt vmcnt(0) lgkmcnt(0)
Lgc_93:
    v_max3_u32 v56, v16, v17, v18
    v_max3_u32 v56, v56, v19, v20
    v_max3_u32 v56, v56, v21, v22
    v_max3_u32 v56, v56, v23, v24
    v_max3_u32 v56, v56, v25, v26
    v_max3_u32 v56, v56, v27, v28
    v_max3_u32 v56, v56, v29, v30
    v_max_u32 v56, v56, v31
    v_cmp_eq_u32 vcc, -1, v56
    s_cbranch_vccz Lgo_94
    s_mov_b64 s[94:95], vcc
    s_sub_u32 s79, s79, 1
    s_cbranch_scc0 Lg_92
    s_branch L_end
Lgo_94:
    v_mfma_f32_16x16x32_bf16 v[48:51], v[16:19], v[32:35], 0
    v_mfma_f32_16x16x32_bf16 v[52:55], v[16:19], v[16:19], 0
    v_mfma_f32_16x16x32_bf16 v[48:51], v[20:23], v[36:39], v[48:51]
    v_mfma_f32_16x16x32_bf16 v[52:55], v[20:23], v[20:23], v[52:55]
    v_mfma_f32_16x16x32_bf16 v[48:51], v[24:27], v[40:43], v[48:51]
    v_mfma_f32_16x16x32_bf16 v[52:55], v[24:27], v[24:27], v[52:55]
    v_mfma_f32_16x16x32_bf16 v[48:51], v[28:31], v[44:47], v[48:51]
    v_mfma_f32_16x16x32_bf16 v[52:55], v[28:31], v[28:31], v[52:55]
    s_nop 7
    ds_write_b32 v15, v48 offset:0
    ds_write_b32 v15, v49 offset:256
    ds_write_b32 v15, v50 offset:512
    ds_write_b32 v15, v51 offset:768
    ds_write_b32 v15, v52 offset:4096
    ds_write_b32 v15, v53 offset:4352
    ds_write_b32 v15, v54 offset:4608
    ds_write_b32 v15, v55 offset:4864
    s_waitcnt lgkmcnt(0)
    s_cbranch_execz Ld_95
    s_barrier
Ld_95:
    s_cbranch_execz L_dryret
Lseg_96:
    s_cmp_lg_u32 s62, 0
    s_cbranch_scc1 Lsk_97
    v_lshrrev_b32 v56, 3, v1
    v_and_b32 v57, 7, v1
    v_lshlrev_b32 v58, 5, v57
    v_lshl_add_u32 v59, v56, 8, v58
    v_mul_u32_u24 v60, 272, v56
    v_lshlrev_b32 v61, 4, v56
    ds_read_b128 v[32:35], v59 offset:0
    ds_read_b128 v[36:39], v59 offset:16
    ds_read_b128 v[40:43], v58 offset:1024
    ds_read_b128 v[44:47], v58 offset:1040
    ds_read_b128 v[64:67], v60 offset:4096
    ds_read_b128 v[68:71], v61 offset:5120
    s_waitcnt lgkmcnt(0)
    v_add_f32 v68, v68, v69
    v_add_f32 v70, v70, v71
    v_add_f32 v72, v68, v70
    v_add_f32 v64, v64, v65
    v_add_f32 v66, v66, v67
    v_add_f32 v73, v64, v66
    v_mul_f32 v72, 0x3b124925, v72
    v_mul_f32 v73, 0x3b124925, v73
    v_fma_f32 v73, -v72, v72, v73
    v_max_f32 v73, 0, v73
    v_add_f32 v73, 0x3727c5ac, v73
    v_rsq_f32 v73, v73
    v_add_f32 v32, v32, v33
    v_add_f32 v34, v34, v35
    v_add_f32 v74, v32, v34
    v_add_f32 v36, v36, v37
    v_add_f32 v38, v38, v39
    v_add_f32 v75, v36, v38
    v_add_f32 v40, v40, v41
    v_add_f32 v42, v42, v43
    v_add_f32 v76, v40, v42
    v_add_f32 v44, v44, v45
    v_add_f32 v46, v46, v47
    v_add_f32 v77, v44, v46
    v_fma_f32 v74, -v72, v76, v74
    v_fma_f32 v75, -v72, v77, v75
    v_mul_f32 v74, v73, v74
    v_mul_f32 v75, v73, v75
    v_cvt_pk_bf16_f32 v94, v74, v75
    v_lshrrev_b32 v56, 3, v1
    v_and_b32 v57, 7, v1
    v_lshlrev_b32 v56, 10, v56
    v_lshl_add_u32 v56, v57, 2, v56
    s_lshl_b32 s78, s74, 5
    s_add_u32 s77, s93, s78
    s_add_u32 s77, s77, 20480
    s_and_b32 exec_lo, s60, 0xffffffff
    s_and_b32 exec_hi, s60, 0x0
    s_cbranch_execz Ld_98
    buffer_store_dword v94, v56, s[12:15], s77 offen
Ld_98:
    s_mov_b64 exec, s[60:61]
Lsk_97:
    ds_read_b128 v[80:83], v92 offset:0
    ds_read_b128 v[84:87], v92 offset:4096
    ds_read_b128 v[88:91], v92 offset:1024
    s_mov_b64 s[94:95], s[60:61]
    s_cbranch_execz Lgc_100
Lg_99:
    s_mov_b64 exec, s[94:95]
    buffer_load_dwordx4 v[16:19], v93, s[12:15], s92 offen offset:0 sc1
    buffer_load_dwordx4 v[20:23], v93, s[12:15], s92 offen offset:128 sc1
    buffer_load_dwordx4 v[24:27], v93, s[12:15], s92 offen offset:256 sc1
    buffer_load_dwordx4 v[28:31], v93, s[12:15], s92 offen offset:384 sc1
    s_mov_b64 exec, s[60:61]
    s_waitcnt vmcnt(0) lgkmcnt(0)
Lgc_100:
    v_max3_u32 v56, v16, v17, v18
    v_max3_u32 v56, v56, v19, v20
    v_max3_u32 v56, v56, v21, v22
    v_max3_u32 v56, v56, v23, v24
    v_max3_u32 v56, v56, v25, v26
    v_max3_u32 v56, v56, v27, v28
    v_max3_u32 v56, v56, v29, v30
    v_max_u32 v56, v56, v31
    v_cmp_eq_u32 vcc, -1, v56
    s_cbranch_vccz Lgo_101
    s_mov_b64 s[94:95], vcc
    s_sub_u32 s79, s79, 1
    s_cbranch_scc0 Lg_99
    s_branch L_end
Lgo_101:
    s_cbranch_execz L_dryret
    s_mov_b32 s63, 1
    s_mov_b32 s66, 0
    s_mov_b32 s67, 0
    s_mov_b32 s68, 256
    s_mov_b32 s69, 512
    s_mov_b32 s70, 8192
    s_branch L_att
L_fix:
    s_waitcnt vmcnt(0)
    s_barrier
    s_cmp_lg_u32 s72, 0
    s_cbranch_scc1 Lfx3
    v_mov_b32 v82, 1
    s_mov_b64 exec, 1
    buffer_atomic_add v82, off, s[44:47], s3 offset:8 sc0 sc1
    s_waitcnt vmcnt(0)
    v_readfirstlane_b32 s77, v82
Lfx1:
    s_sub_u32 s79, s79, 1
    s_cbranch_scc1 L_end
    buffer_load_dwordx4 v[84:87], off, s[44:47], s3 sc1
    s_waitcnt vmcnt(0)
    v_add_u32 v85, v85, v86
    s_nop 0
    v_readfirstlane_b32 s90, v85
    s_cmp_lt_u32 s90, 32
    s_cbranch_scc1 Lfx1
    buffer_load_dword v84, off, s[44:47], s3 sc1
    s_waitcnt vmcnt(0)
    v_readfirstlane_b32 s90, v84
    s_not_b32 s90, s90
Lfx2:
    s_ff1_i32_b32 s91, s90
    s_bitset0_b32 s90, s91
    s_sub_u32 s77, s77, 1
    s_cbranch_scc0 Lfx2
    v_mov_b32 v56, s91
    v_mov_b32 v57, 0
    ds_write_b32 v57, v56 offset:12192
    s_mov_b64 exec, -1
Lfx3:
    s_load_dwordx16 s[48:63], s[0:1], 0
    s_load_dwordx8 s[64:71], s[0:1], 64
    s_waitcnt lgkmcnt(0)
    s_barrier
    v_mov_b32 v57, 0
    ds_read_b32 v56, v57 offset:12192
    v_mov_b32 v82, 0
    s_waitcnt lgkmcnt(0)
    v_readfirstlane_b32 s74, v56
    s_cmp_ge_u32 s74, 32
    s_cbranch_scc1 L_end
    s_barrier
    s_branch L_role
L_dryret:
    s_mov_b64 exec, -1
    s_mov_b64 s[60:61], -1
    s_mov_b32 s62, s72
    s_setpc_b64 s[64:65]
L_slot:
    s_cmp_eq_u32 s57, 1
    s_cbranch_scc1 Ls1
    v_cmp_le_u32 vcc, 32, v83
    s_and_b32 s90, vcc_lo, 0xff
    s_cmp_eq_u32 s90, 0xff
    s_cbranch_scc1 Ls0ok
    buffer_load_dword v83, v8, s[44:47], 0 offen offset:132 sc1
    s_setpc_b64 s[58:59]
Ls0ok:
    v_lshrrev_b32 v56, 3, v1
    v_and_b32 v57, 7, v1
    v_lshlrev_b32 v56, 10, v56
    v_lshl_add_u32 v56, v57, 2, v56
    s_lshl_b32 s78, s74, 5
    s_add_u32 s77, s93, s78
    s_add_u32 s77, s77, 16384
    s_and_b32 exec_lo, s60, 0xffffffff
    s_and_b32 exec_hi, s60, 0x0
    s_cbranch_execz Ld_102
    buffer_store_dword v94, v56, s[12:15], s77 offen
Ld_102:
    s_mov_b64 exec, s[60:61]
    s_mov_b32 s57, 1
Lsq:
    buffer_load_dwordx4 v[84:87], v8, s[12:15], s92 offen sc1
    s_setpc_b64 s[58:59]
Ls1:
    v_max3_u32 v56, v84, v85, v86
    v_max_u32 v56, v56, v87
    v_cmp_eq_u32 vcc, -1, v56
    s_cbranch_vccnz Lsq
    ds_write_b128 v8, v[84:87] offset:9216
    s_mov_b32 s57, 3
    s_setpc_b64 s[58:59]
L_final:
    s_cmp_ge_u32 s62, 2
    s_cbranch_scc1 Lrsk_103
    s_and_b32 s77, s74, 7
    s_xor_b32 s77, s77, s73
    s_and_b32 s77, s77, s60
    s_cbranch_scc1 Lrsk_103
    v_lshrrev_b32 v60, 3, v1
    s_mul_i32 s89, s72, 7
    v_add_u32 v60, s89, v60
    v_lshrrev_b32 v61, 1, v60
    s_mul_i32 s89, s74, 7
    v_add_u32 v61, s89, v61
    v_and_b32 v62, 1, v60
    v_bfe_u32 v63, v61, 3, 1
    v_lshl_add_u32 v62, v62, 1, v63
    v_mul_u32_u24 v62, 896, v62
    v_lshrrev_b32 v63, 4, v61
    v_lshl_add_u32 v62, v63, 6, v62
    v_and_b32 v63, 7, v61
    v_lshl_add_u32 v57, v63, 1, v62
    v_and_b32 v56, 7, v1
    v_lshlrev_b32 v56, 10, v56
    v_lshl_add_u32 v56, v60, 4, v56
    s_lshl_b32 s77, s74, 13
    s_add_u32 s77, s77, 262400
    s_add_u32 s77, s77, s69
    v_mov_b32 v48, 0
    v_mov_b32 v49, 0
    v_mov_b32 v50, 0
    v_mov_b32 v51, 0
    v_lshlrev_b32 v20, 16, v9
    v_and_b32 v21, 0xffff0000, v9
    v_lshlrev_b32 v22, 16, v0
    v_and_b32 v23, 0xffff0000, v0
    s_mov_b64 s[94:95], s[60:61]
    s_cbranch_execz Lgc_105
    s_sleep 6
Lg_104:
    s_and_b64 exec, s[94:95], s[100:101]
    buffer_load_dwordx4 v[48:51], v56, s[12:15], s77 offen sc1
    s_mov_b64 exec, s[60:61]
    s_waitcnt vmcnt(0) lgkmcnt(0)
Lgc_105:
    v_max3_u32 v59, v48, v49, v50
    v_max_u32 v59, v59, v51
    v_cmp_eq_u32 vcc, -1, v59
    s_cbranch_vccz Lgo_106
    s_mov_b64 s[94:95], vcc
    s_sub_u32 s79, s79, 1
    s_cbranch_scc0 Lg_104
    s_branch L_end
Lgo_106:
    v_add_f32_dpp v16, v48, v48 quad_perm:[1,0,3,2] row_mask:0xf bank_mask:0xf
    v_add_f32_dpp v17, v49, v49 quad_perm:[1,0,3,2] row_mask:0xf bank_mask:0xf
    v_add_f32_dpp v18, v50, v50 quad_perm:[1,0,3,2] row_mask:0xf bank_mask:0xf
    v_add_f32_dpp v19, v51, v51 quad_perm:[1,0,3,2] row_mask:0xf bank_mask:0xf
    v_add_f32_dpp v16, v16, v16 quad_perm:[2,3,0,1] row_mask:0xf bank_mask:0xf
    v_add_f32_dpp v17, v17, v17 quad_perm:[2,3,0,1] row_mask:0xf bank_mask:0xf
    v_add_f32_dpp v18, v18, v18 quad_perm:[2,3,0,1] row_mask:0xf bank_mask:0xf
    v_add_f32_dpp v19, v19, v19 quad_perm:[2,3,0,1] row_mask:0xf bank_mask:0xf
    v_add_f32_dpp v16, v16, v16 row_half_mirror row_mask:0xf bank_mask:0xf
    v_add_f32_dpp v17, v17, v17 row_half_mirror row_mask:0xf bank_mask:0xf
    v_add_f32_dpp v18, v18, v18 row_half_mirror row_mask:0xf bank_mask:0xf
    v_add_f32_dpp v19, v19, v19 row_half_mirror row_mask:0xf bank_mask:0xf
    v_cvt_pk_bf16_f32 v16, v16, v16
    v_and_b32 v16, 0xffff0000, v16
    v_cvt_pk_bf16_f32 v17, v17, v17
    v_and_b32 v17, 0xffff0000, v17
    v_cvt_pk_bf16_f32 v18, v18, v18
    v_and_b32 v18, 0xffff0000, v18
    v_cvt_pk_bf16_f32 v19, v19, v19
    v_and_b32 v19, 0xffff0000, v19
    v_add_f32 v16, v16, v20
    v_add_f32 v17, v17, v21
    v_add_f32 v18, v18, v22
    v_add_f32 v19, v19, v23
    v_cvt_pk_bf16_f32 v24, v16, v17
    v_cvt_pk_bf16_f32 v25, v18, v19
    s_and_b32 exec_lo, s60, 0x1010101
    s_and_b32 exec_hi, s60, 0x10101
    s_cbranch_execz Ld_107
    buffer_store_short v24, v57, s[40:43], 0 offen
    buffer_store_short_d16_hi v24, v57, s[40:43], 0 offen offset:16
Ld_107:
    s_cbranch_execz Ld_108
    buffer_store_short v25, v57, s[40:43], 0 offen offset:32
    buffer_store_short_d16_hi v25, v57, s[40:43], 0 offen offset:48
Ld_108:
    s_mov_b64 exec, s[60:61]
Lrsk_103:
    s_cbranch_execz L_dryret
L_end:
    s_waitcnt vmcnt(0)
    s_endpgm
.section .rodata,"a"
.p2align 6
.amdhsa_kernel interleave_layers__gqa_block_cached__geglu_ffn__decode_kernel
  .amdhsa_next_free_vgpr 512
  .amdhsa_next_free_sgpr 102
  .amdhsa_accum_offset 256
  .amdhsa_group_segment_fixed_size 0
  .amdhsa_kernarg_size 96
  .amdhsa_user_sgpr_count 2
  .amdhsa_user_sgpr_kernarg_segment_ptr 1
  .amdhsa_system_sgpr_workgroup_id_x 1
.end_amdhsa_kernel
```
